```python
import torch

def _softmax(x, axis=-1):
    return torch.softmax(x, dim=axis)

def _gelu(x):
    return torch.nn.functional.gelu(x, approximate='tanh')

def _silu(x):
    return torch.nn.functional.silu(x)

def _sigmoid(x):
    return torch.sigmoid(x)

def _layernorm(x, axis=-1, eps=1e-05):
    m = x.mean(dim=axis, keepdim=True)
    v = x.var(dim=axis, keepdim=True, unbiased=False)
    return (x - m) / torch.sqrt(v + eps)

def _scatter_add(tgt, idx, src, axis=0):
    return tgt.clone().index_add_(axis, idx, src)

def _segment_sum(src, seg, n):
    out = torch.zeros((n,) + src.shape[1:], dtype=src.dtype)
    return out.index_add_(0, seg, src)

def _pad(x, pw):
    flat = tuple((v for pair in reversed(pw) for v in pair))
    return torch.nn.functional.pad(x, flat)
kernel_name = 'adaLN_cond__softmax_full_mha__dense_activation_silu__prompt'

def setup_inputs():

    _w = lambda a: (lambda t: t.to(torch.bfloat16) if t.is_floating_point() else t)(torch.as_tensor(a))

    def _A_setup():
        B, S, D = (1, 2048, 576)
        return {'x': _w((lambda *s: torch.randn(*s, dtype=torch.bfloat16) * 0.05)(B, S, D)), 'wqkv': _w((lambda *s: torch.randn(*s, dtype=torch.bfloat16) * 0.05)(D, 3 * D)), 'wo': _w((lambda *s: torch.randn(*s, dtype=torch.bfloat16) * 0.05)(D, D))}
    _A_in = _A_setup()

    def _B_setup():
        B, S, D, F = (1, 2048, 576, 4608)
        return {'x': _w((lambda *s: torch.randn(*s, dtype=torch.bfloat16) * 0.05)(B, S, D)), 'w1': _w((lambda *s: torch.randn(*s, dtype=torch.bfloat16) * 3.2)(D, F) * D ** (-0.5)), 'w2': _w((lambda *s: torch.randn(*s, dtype=torch.bfloat16) * 0.4)(F, D) * F ** (-0.5))}
    _B_in = _B_setup()
    return {'A_x': _A_in['x'], 'A_wqkv': _A_in['wqkv'], 'A_wo': _A_in['wo'], 'B_x': _B_in['x'], 'B_w1': _B_in['w1'], 'B_w2': _B_in['w2'], 'c': _w((lambda *s: torch.randn(*s, dtype=torch.bfloat16) * 0.1)(1, 576) * 8.0), 'w_mod': _w((lambda *s: torch.randn(*s, dtype=torch.bfloat16) * 0.1)(576, 6 * 576) * 576 ** (-0.5) * 8.0)}

def reference(A_x, A_wqkv, A_wo, B_x, B_w1, B_w2, c, w_mod):

    def _A_ref(x, wqkv, wo):
        B, S, D = x.shape
        H = 32
        Dh = D // H
        qkv = (lambda x, *d: x.permute(*d))((x @ wqkv).reshape(B, S, 3, H, Dh), 2, 0, 3, 1, 4)
        q, k, v = (qkv[0], qkv[1], qkv[2])
        scale = Dh ** (-0.5)
        scores = torch.einsum('bhqd,bhkd->bhqk', q, k) * scale
        p = _softmax(scores, axis=-1)
        o = torch.einsum('bhqk,bhkd->bhqd', p, v)
        return (lambda x, *d: x.permute(*d))(o, 0, 2, 1, 3).reshape(B, S, D) @ wo

    def _B_ref(x, w1, w2):
        h = torch.einsum('bsd,df->bsf', x, w1)
        h = _silu(h)
        out = torch.einsum('bsf,fd->bsd', h, w2)
        return out
    x = A_x
    mod = (_silu(c) @ w_mod).reshape(c.shape[0], 6, 1, -1)
    sa, ca, ga, sb, cb, gb = (mod[:, 0].clone(), mod[:, 1].clone(), mod[:, 2].clone(), mod[:, 3].clone(), mod[:, 4].clone(), mod[:, 5].clone())
    h = _layernorm(x, axis=-1) * (1 + ca) + sa
    x = x + ga * _A_ref(h, A_wqkv, A_wo)
    h = _layernorm(x, axis=-1) * (1 + cb) + sb
    x = x + gb * _B_ref(h, B_w1, B_w2)
    return x
```

```asm
; @launch kernel=prep_kernel grid=(704,1,1) block=(256,1,1) lds=1024
; @launch kernel=main_kernel grid=(256,1,1) block=(768,1,1) lds=158912
.amdgcn_target "amdgcn-amd-amdhsa--gfx950"
.text
.globl prep_kernel
.p2align 8
.type prep_kernel,@function
prep_kernel:
  s_load_dwordx2 s[4:5], s[0:1], 80
  s_cmp_lt_u32 s2, 32
  s_cbranch_scc1 D_prep_1
  s_sub_u32 s2, s2, 32
  s_cmp_ge_u32 s2, 224
  s_cbranch_scc1 B_prep_2
  s_load_dwordx4 s[8:11], s[0:1], 48
  s_lshr_b32 s3, s2, 5
  s_lshl_b32 s3, s3, 3
  s_and_b32 s6, s2, 7
  s_add_u32 s3, s3, s6
  s_cmp_ge_u32 s3, 54
  s_cbranch_scc1 Z_prep_5
  s_lshr_b32 s6, s2, 3
  s_and_b32 s6, s6, 3
  s_lshl_b32 s3, s3, 2
  s_add_u32 s3, s3, s6
  s_lshl_b32 s7, s3, 5
  v_lshrrev_b32 v1, 1, v0
  v_and_b32 v2, 1, v0
  v_mul_u32_u24 v3, 6912, v1
  v_lshl_add_u32 v3, v2, 4, v3
  v_add_u32 v3, s7, v3
  v_lshlrev_b32 v4, 1, v1
  s_waitcnt lgkmcnt(0)
  s_mov_b32 s12, s8
  s_mov_b32 s13, s9
  s_mov_b32 s14, 0x480
  s_mov_b32 s15, 0x20000
  s_mov_b32 s16, s10
  s_mov_b32 s17, s11
  s_mov_b32 s18, 0x3cc000
  s_mov_b32 s19, 0x20000
  s_mov_b32 s20, s4
  s_mov_b32 s21, s5
  s_mov_b32 s22, 0x5b00
  s_mov_b32 s23, 0x20000
  buffer_load_ushort v10, v4, s[12:15], 0 offen offset:0
  buffer_load_ushort v11, v4, s[12:15], 0 offen offset:256
  buffer_load_ushort v12, v4, s[12:15], 0 offen offset:512
  buffer_load_ushort v13, v4, s[12:15], 0 offen offset:768
  buffer_load_ushort v14, v4, s[12:15], 0 offen offset:1024
  buffer_load_dwordx4 v[16:19], v3, s[16:19], 0 offen
  v_add_u32 v3, 884736, v3
  buffer_load_dwordx4 v[20:23], v3, s[16:19], 0 offen
  v_add_u32 v3, 884736, v3
  buffer_load_dwordx4 v[24:27], v3, s[16:19], 0 offen
  v_add_u32 v3, 884736, v3
  buffer_load_dwordx4 v[28:31], v3, s[16:19], 0 offen
  v_add_u32 v3, 884736, v3
  buffer_load_dwordx4 v[32:35], v3, s[16:19], 0 offen
  v_mov_b32 v40, 0
  v_mov_b32 v41, 0
  v_mov_b32 v42, 0
  v_mov_b32 v43, 0
  v_mov_b32 v44, 0
  v_mov_b32 v45, 0
  v_mov_b32 v46, 0
  v_mov_b32 v47, 0
  s_waitcnt vmcnt(5)
  v_lshlrev_b32 v10, 16, v10
  v_mul_f32 v5, 0xbfb8aa3b, v10
  v_exp_f32 v5, v5
  s_nop 0
  v_add_f32 v5, 1.0, v5
  v_rcp_f32 v5, v5
  s_nop 0
  v_mul_f32 v10, v10, v5
  v_cvt_pk_bf16_f32 v10, v10, v10
  v_lshlrev_b32 v10, 16, v10
  v_lshlrev_b32 v11, 16, v11
  v_mul_f32 v5, 0xbfb8aa3b, v11
  v_exp_f32 v5, v5
  s_nop 0
  v_add_f32 v5, 1.0, v5
  v_rcp_f32 v5, v5
  s_nop 0
  v_mul_f32 v11, v11, v5
  v_cvt_pk_bf16_f32 v11, v11, v11
  v_lshlrev_b32 v11, 16, v11
  v_lshlrev_b32 v12, 16, v12
  v_mul_f32 v5, 0xbfb8aa3b, v12
  v_exp_f32 v5, v5
  s_nop 0
  v_add_f32 v5, 1.0, v5
  v_rcp_f32 v5, v5
  s_nop 0
  v_mul_f32 v12, v12, v5
  v_cvt_pk_bf16_f32 v12, v12, v12
  v_lshlrev_b32 v12, 16, v12
  v_lshlrev_b32 v13, 16, v13
  v_mul_f32 v5, 0xbfb8aa3b, v13
  v_exp_f32 v5, v5
  s_nop 0
  v_add_f32 v5, 1.0, v5
  v_rcp_f32 v5, v5
  s_nop 0
  v_mul_f32 v13, v13, v5
  v_cvt_pk_bf16_f32 v13, v13, v13
  v_lshlrev_b32 v13, 16, v13
  v_lshlrev_b32 v14, 16, v14
  v_mul_f32 v5, 0xbfb8aa3b, v14
  v_exp_f32 v5, v5
  s_nop 0
  v_add_f32 v5, 1.0, v5
  v_rcp_f32 v5, v5
  s_nop 0
  v_mul_f32 v14, v14, v5
  v_cvt_pk_bf16_f32 v14, v14, v14
  v_lshlrev_b32 v14, 16, v14
  s_waitcnt vmcnt(4)
  v_lshlrev_b32 v5, 16, v16
  v_and_b32 v6, 0xffff0000, v16
  v_fmac_f32 v40, v10, v5
  v_fmac_f32 v41, v10, v6
  v_lshlrev_b32 v5, 16, v17
  v_and_b32 v6, 0xffff0000, v17
  v_fmac_f32 v42, v10, v5
  v_fmac_f32 v43, v10, v6
  v_lshlrev_b32 v5, 16, v18
  v_and_b32 v6, 0xffff0000, v18
  v_fmac_f32 v44, v10, v5
  v_fmac_f32 v45, v10, v6
  v_lshlrev_b32 v5, 16, v19
  v_and_b32 v6, 0xffff0000, v19
  v_fmac_f32 v46, v10, v5
  v_fmac_f32 v47, v10, v6
  s_waitcnt vmcnt(3)
  v_lshlrev_b32 v5, 16, v20
  v_and_b32 v6, 0xffff0000, v20
  v_fmac_f32 v40, v11, v5
  v_fmac_f32 v41, v11, v6
  v_lshlrev_b32 v5, 16, v21
  v_and_b32 v6, 0xffff0000, v21
  v_fmac_f32 v42, v11, v5
  v_fmac_f32 v43, v11, v6
  v_lshlrev_b32 v5, 16, v22
  v_and_b32 v6, 0xffff0000, v22
  v_fmac_f32 v44, v11, v5
  v_fmac_f32 v45, v11, v6
  v_lshlrev_b32 v5, 16, v23
  v_and_b32 v6, 0xffff0000, v23
  v_fmac_f32 v46, v11, v5
  v_fmac_f32 v47, v11, v6
  s_waitcnt vmcnt(2)
  v_lshlrev_b32 v5, 16, v24
  v_and_b32 v6, 0xffff0000, v24
  v_fmac_f32 v40, v12, v5
  v_fmac_f32 v41, v12, v6
  v_lshlrev_b32 v5, 16, v25
  v_and_b32 v6, 0xffff0000, v25
  v_fmac_f32 v42, v12, v5
  v_fmac_f32 v43, v12, v6
  v_lshlrev_b32 v5, 16, v26
  v_and_b32 v6, 0xffff0000, v26
  v_fmac_f32 v44, v12, v5
  v_fmac_f32 v45, v12, v6
  v_lshlrev_b32 v5, 16, v27
  v_and_b32 v6, 0xffff0000, v27
  v_fmac_f32 v46, v12, v5
  v_fmac_f32 v47, v12, v6
  s_waitcnt vmcnt(1)
  v_lshlrev_b32 v5, 16, v28
  v_and_b32 v6, 0xffff0000, v28
  v_fmac_f32 v40, v13, v5
  v_fmac_f32 v41, v13, v6
  v_lshlrev_b32 v5, 16, v29
  v_and_b32 v6, 0xffff0000, v29
  v_fmac_f32 v42, v13, v5
  v_fmac_f32 v43, v13, v6
  v_lshlrev_b32 v5, 16, v30
  v_and_b32 v6, 0xffff0000, v30
  v_fmac_f32 v44, v13, v5
  v_fmac_f32 v45, v13, v6
  v_lshlrev_b32 v5, 16, v31
  v_and_b32 v6, 0xffff0000, v31
  v_fmac_f32 v46, v13, v5
  v_fmac_f32 v47, v13, v6
  s_waitcnt vmcnt(0)
  v_lshlrev_b32 v5, 16, v32
  v_and_b32 v6, 0xffff0000, v32
  v_fmac_f32 v40, v14, v5
  v_fmac_f32 v41, v14, v6
  v_lshlrev_b32 v5, 16, v33
  v_and_b32 v6, 0xffff0000, v33
  v_fmac_f32 v42, v14, v5
  v_fmac_f32 v43, v14, v6
  v_lshlrev_b32 v5, 16, v34
  v_and_b32 v6, 0xffff0000, v34
  v_fmac_f32 v44, v14, v5
  v_fmac_f32 v45, v14, v6
  v_lshlrev_b32 v5, 16, v35
  v_and_b32 v6, 0xffff0000, v35
  v_fmac_f32 v46, v14, v5
  v_fmac_f32 v47, v14, v6
  v_add_f32_dpp v40, v40, v40 quad_perm:[2,3,0,1] row_mask:0xf bank_mask:0xf
  v_add_f32_dpp v41, v41, v41 quad_perm:[2,3,0,1] row_mask:0xf bank_mask:0xf
  v_add_f32_dpp v42, v42, v42 quad_perm:[2,3,0,1] row_mask:0xf bank_mask:0xf
  v_add_f32_dpp v43, v43, v43 quad_perm:[2,3,0,1] row_mask:0xf bank_mask:0xf
  v_add_f32_dpp v44, v44, v44 quad_perm:[2,3,0,1] row_mask:0xf bank_mask:0xf
  v_add_f32_dpp v45, v45, v45 quad_perm:[2,3,0,1] row_mask:0xf bank_mask:0xf
  v_add_f32_dpp v46, v46, v46 quad_perm:[2,3,0,1] row_mask:0xf bank_mask:0xf
  v_add_f32_dpp v47, v47, v47 quad_perm:[2,3,0,1] row_mask:0xf bank_mask:0xf
  v_add_f32_dpp v40, v40, v40 row_ror:4 row_mask:0xf bank_mask:0xf
  v_add_f32_dpp v41, v41, v41 row_ror:4 row_mask:0xf bank_mask:0xf
  v_add_f32_dpp v42, v42, v42 row_ror:4 row_mask:0xf bank_mask:0xf
  v_add_f32_dpp v43, v43, v43 row_ror:4 row_mask:0xf bank_mask:0xf
  v_add_f32_dpp v44, v44, v44 row_ror:4 row_mask:0xf bank_mask:0xf
  v_add_f32_dpp v45, v45, v45 row_ror:4 row_mask:0xf bank_mask:0xf
  v_add_f32_dpp v46, v46, v46 row_ror:4 row_mask:0xf bank_mask:0xf
  v_add_f32_dpp v47, v47, v47 row_ror:4 row_mask:0xf bank_mask:0xf
  v_add_f32_dpp v40, v40, v40 row_ror:8 row_mask:0xf bank_mask:0xf
  v_add_f32_dpp v41, v41, v41 row_ror:8 row_mask:0xf bank_mask:0xf
  v_add_f32_dpp v42, v42, v42 row_ror:8 row_mask:0xf bank_mask:0xf
  v_add_f32_dpp v43, v43, v43 row_ror:8 row_mask:0xf bank_mask:0xf
  v_add_f32_dpp v44, v44, v44 row_ror:8 row_mask:0xf bank_mask:0xf
  v_add_f32_dpp v45, v45, v45 row_ror:8 row_mask:0xf bank_mask:0xf
  v_add_f32_dpp v46, v46, v46 row_ror:8 row_mask:0xf bank_mask:0xf
  v_add_f32_dpp v47, v47, v47 row_ror:8 row_mask:0xf bank_mask:0xf
  v_lshrrev_b32 v5, 4, v0
  v_lshlrev_b32 v5, 6, v5
  v_lshl_add_u32 v5, v2, 5, v5
  v_and_b32 v6, 15, v0
  v_cmp_gt_u32 vcc, 2, v6
  s_and_saveexec_b64 s[24:25], vcc
  ds_write_b128 v5, v[40:43]
  ds_write_b128 v5, v[44:47] offset:16
  s_mov_b64 exec, s[24:25]
  s_waitcnt lgkmcnt(0)
  s_barrier
  v_cmp_gt_u32 vcc, 16, v0
  v_lshlrev_b32 v5, 2, v0
  s_lshl_b32 s7, s3, 4
  v_add_u32 v7, s7, v0
  v_lshlrev_b32 v8, 2, v7
  v_lshlrev_b32 v9, 1, v7
  v_add_u32 v9, 16384, v9
  s_and_saveexec_b64 s[24:25], vcc
  s_cbranch_execz E_prep_4
  ds_read_b32 v16, v5 offset:0
  ds_read_b32 v17, v5 offset:64
  ds_read_b32 v18, v5 offset:128
  ds_read_b32 v19, v5 offset:192
  ds_read_b32 v20, v5 offset:256
  ds_read_b32 v21, v5 offset:320
  ds_read_b32 v22, v5 offset:384
  ds_read_b32 v23, v5 offset:448
  ds_read_b32 v24, v5 offset:512
  ds_read_b32 v25, v5 offset:576
  ds_read_b32 v26, v5 offset:640
  ds_read_b32 v27, v5 offset:704
  ds_read_b32 v28, v5 offset:768
  ds_read_b32 v29, v5 offset:832
  ds_read_b32 v30, v5 offset:896
  ds_read_b32 v31, v5 offset:960
  s_waitcnt lgkmcnt(0)
  v_add_f32 v16, v16, v24
  v_add_f32 v17, v17, v25
  v_add_f32 v18, v18, v26
  v_add_f32 v19, v19, v27
  v_add_f32 v20, v20, v28
  v_add_f32 v21, v21, v29
  v_add_f32 v22, v22, v30
  v_add_f32 v23, v23, v31
  v_add_f32 v16, v16, v20
  v_add_f32 v17, v17, v21
  v_add_f32 v18, v18, v22
  v_add_f32 v19, v19, v23
  v_add_f32 v16, v16, v18
  v_add_f32 v17, v17, v19
  v_add_f32 v16, v16, v17
  v_cvt_pk_bf16_f32 v16, v16, v16
  v_lshlrev_b32 v16, 16, v16
  s_mov_b32 s6, 0
  s_cmp_ge_u32 s3, 36
  s_cselect_b32 s6, 1.0, s6
  s_cmp_ge_u32 s3, 72
  s_cselect_b32 s6, 0, s6
  s_cmp_ge_u32 s3, 144
  s_cselect_b32 s6, 1.0, s6
  s_cmp_ge_u32 s3, 180
  s_cselect_b32 s6, 0, s6
  v_add_f32 v16, s6, v16
  v_cvt_pk_bf16_f32 v17, v16, v16
  v_lshlrev_b32 v16, 16, v17
  buffer_store_dword v16, v8, s[20:23], 0 offen
  buffer_store_short v17, v9, s[20:23], 0 offen
  s_endpgm
Z_prep_5:
  v_lshlrev_b32 v1, 4, v0
  v_mov_b32 v4, 0
  v_mov_b32 v5, 0
  v_mov_b32 v6, 0
  v_mov_b32 v7, 0
  s_waitcnt lgkmcnt(0)
  s_add_u32 s16, s4, 0x6000
  s_addc_u32 s17, s5, 0
  s_mov_b32 s18, 0x20000
  s_mov_b32 s19, 0x20000
  s_bfe_u32 s6, s2, 0x20003
  s_and_b32 s7, s2, 1
  s_lshl1_add_u32 s6, s6, s7
  s_lshl_b32 s6, s6, 14
  buffer_store_dwordx4 v[4:7], v1, s[16:19], s6 offen
  s_add_u32 s6, s6, 4096
  buffer_store_dwordx4 v[4:7], v1, s[16:19], s6 offen
  s_add_u32 s6, s6, 4096
  buffer_store_dwordx4 v[4:7], v1, s[16:19], s6 offen
  s_add_u32 s6, s6, 4096
  buffer_store_dwordx4 v[4:7], v1, s[16:19], s6 offen
  s_endpgm
B_prep_2:
  s_cmp_ge_u32 s2, 480
  s_cbranch_scc1 C_prep_3
  s_load_dwordx2 s[8:9], s[0:1], 0
  s_sub_u32 s3, s2, 224
  s_lshl_b32 s3, s3, 3
  v_lshrrev_b32 v1, 5, v0
  v_add_u32 v1, s3, v1
  v_and_b32 v2, 31, v0
  v_mul_u32_u24 v3, 1152, v1
  v_lshl_add_u32 v3, v2, 4, v3
  v_lshrrev_b32 v4, 5, v1
  v_mul_u32_u24 v4, 36864, v4
  v_and_b32 v5, 31, v1
  v_lshl_add_u32 v4, v5, 4, v4
  v_lshl_add_u32 v4, v2, 9, v4
  v_cmp_gt_u32 vcc, 24, v2
  v_bfrev_b32 v5, 1
  s_nop 0
  v_cndmask_b32 v3, v5, v3, vcc
  v_cndmask_b32 v4, v5, v4, vcc
  s_waitcnt lgkmcnt(0)
  s_mov_b32 s12, s8
  s_mov_b32 s13, s9
  s_mov_b32 s14, 0x240000
  s_mov_b32 s15, 0x20000
  s_add_u32 s16, s4, 0x26000
  s_addc_u32 s17, s5, 0
  s_mov_b32 s18, 0x240000
  s_mov_b32 s19, 0x20000
  buffer_load_dwordx4 v[8:11], v3, s[12:15], 0 offen offset:0
  buffer_load_dwordx4 v[12:15], v3, s[12:15], 0 offen offset:384
  buffer_load_dwordx4 v[16:19], v3, s[12:15], 0 offen offset:768
  s_add_u32 s24, s4, 0xba6000
  s_addc_u32 s25, s5, 0
  s_mov_b32 s26, 0x240000
  s_mov_b32 s27, 0x20000
  v_mov_b32 v44, -1
  v_mov_b32 v45, -1
  v_mov_b32 v46, -1
  v_mov_b32 v47, -1
  buffer_store_dwordx4 v[44:47], v3, s[24:27], 0 offen offset:0 sc1
  buffer_store_dwordx4 v[44:47], v3, s[24:27], 0 offen offset:384 sc1
  buffer_store_dwordx4 v[44:47], v3, s[24:27], 0 offen offset:768 sc1
  s_waitcnt vmcnt(3)
  v_lshlrev_b32 v20, 16, v8
  v_and_b32 v21, 0xffff0000, v8
  v_lshlrev_b32 v22, 16, v9
  v_and_b32 v23, 0xffff0000, v9
  v_lshlrev_b32 v24, 16, v10
  v_and_b32 v25, 0xffff0000, v10
  v_lshlrev_b32 v26, 16, v11
  v_and_b32 v27, 0xffff0000, v11
  v_lshlrev_b32 v28, 16, v12
  v_and_b32 v29, 0xffff0000, v12
  v_lshlrev_b32 v30, 16, v13
  v_and_b32 v31, 0xffff0000, v13
  v_lshlrev_b32 v32, 16, v14
  v_and_b32 v33, 0xffff0000, v14
  v_lshlrev_b32 v34, 16, v15
  v_and_b32 v35, 0xffff0000, v15
  v_lshlrev_b32 v36, 16, v16
  v_and_b32 v37, 0xffff0000, v16
  v_lshlrev_b32 v38, 16, v17
  v_and_b32 v39, 0xffff0000, v17
  v_lshlrev_b32 v40, 16, v18
  v_and_b32 v41, 0xffff0000, v18
  v_lshlrev_b32 v42, 16, v19
  v_and_b32 v43, 0xffff0000, v19
  v_add_f32 v6, v20, v21
  v_add_f32 v7, v22, v23
  v_add_f32 v6, v6, v24
  v_add_f32 v7, v7, v25
  v_add_f32 v6, v6, v26
  v_add_f32 v7, v7, v27
  v_add_f32 v6, v6, v28
  v_add_f32 v7, v7, v29
  v_add_f32 v6, v6, v30
  v_add_f32 v7, v7, v31
  v_add_f32 v6, v6, v32
  v_add_f32 v7, v7, v33
  v_add_f32 v6, v6, v34
  v_add_f32 v7, v7, v35
  v_add_f32 v6, v6, v36
  v_add_f32 v7, v7, v37
  v_add_f32 v6, v6, v38
  v_add_f32 v7, v7, v39
  v_add_f32 v6, v6, v40
  v_add_f32 v7, v7, v41
  v_add_f32 v6, v6, v42
  v_add_f32 v7, v7, v43
  v_add_f32 v6, v6, v7
  s_nop 1
  v_add_f32_dpp v6, v6, v6 quad_perm:[1,0,3,2] row_mask:0xf bank_mask:0xf
  s_nop 1
  v_add_f32_dpp v6, v6, v6 quad_perm:[2,3,0,1] row_mask:0xf bank_mask:0xf
  s_nop 1
  v_add_f32_dpp v6, v6, v6 row_ror:4 row_mask:0xf bank_mask:0xf
  s_nop 1
  v_add_f32_dpp v6, v6, v6 row_ror:8 row_mask:0xf bank_mask:0xf
  v_mov_b32 v7, v6
  s_nop 1
  v_permlane16_swap_b32 v6, v7
  v_add_f32 v6, v6, v7
  v_mul_f32 v6, 0x3ae38e39, v6
  v_mov_b32 v8, 0
  v_mov_b32 v9, 0
  v_sub_f32 v10, v20, v6
  v_sub_f32 v11, v21, v6
  v_fmac_f32 v8, v10, v10
  v_fmac_f32 v9, v11, v11
  v_sub_f32 v10, v22, v6
  v_sub_f32 v11, v23, v6
  v_fmac_f32 v8, v10, v10
  v_fmac_f32 v9, v11, v11
  v_sub_f32 v10, v24, v6
  v_sub_f32 v11, v25, v6
  v_fmac_f32 v8, v10, v10
  v_fmac_f32 v9, v11, v11
  v_sub_f32 v10, v26, v6
  v_sub_f32 v11, v27, v6
  v_fmac_f32 v8, v10, v10
  v_fmac_f32 v9, v11, v11
  v_sub_f32 v10, v28, v6
  v_sub_f32 v11, v29, v6
  v_fmac_f32 v8, v10, v10
  v_fmac_f32 v9, v11, v11
  v_sub_f32 v10, v30, v6
  v_sub_f32 v11, v31, v6
  v_fmac_f32 v8, v10, v10
  v_fmac_f32 v9, v11, v11
  v_sub_f32 v10, v32, v6
  v_sub_f32 v11, v33, v6
  v_fmac_f32 v8, v10, v10
  v_fmac_f32 v9, v11, v11
  v_sub_f32 v10, v34, v6
  v_sub_f32 v11, v35, v6
  v_fmac_f32 v8, v10, v10
  v_fmac_f32 v9, v11, v11
  v_sub_f32 v10, v36, v6
  v_sub_f32 v11, v37, v6
  v_fmac_f32 v8, v10, v10
  v_fmac_f32 v9, v11, v11
  v_sub_f32 v10, v38, v6
  v_sub_f32 v11, v39, v6
  v_fmac_f32 v8, v10, v10
  v_fmac_f32 v9, v11, v11
  v_sub_f32 v10, v40, v6
  v_sub_f32 v11, v41, v6
  v_fmac_f32 v8, v10, v10
  v_fmac_f32 v9, v11, v11
  v_sub_f32 v10, v42, v6
  v_sub_f32 v11, v43, v6
  v_fmac_f32 v8, v10, v10
  v_fmac_f32 v9, v11, v11
  v_add_f32 v8, v8, v9
  v_cndmask_b32 v8, 0, v8, vcc
  s_nop 1
  v_add_f32_dpp v8, v8, v8 quad_perm:[1,0,3,2] row_mask:0xf bank_mask:0xf
  s_nop 1
  v_add_f32_dpp v8, v8, v8 quad_perm:[2,3,0,1] row_mask:0xf bank_mask:0xf
  s_nop 1
  v_add_f32_dpp v8, v8, v8 row_ror:4 row_mask:0xf bank_mask:0xf
  s_nop 1
  v_add_f32_dpp v8, v8, v8 row_ror:8 row_mask:0xf bank_mask:0xf
  v_mov_b32 v7, v8
  s_nop 1
  v_permlane16_swap_b32 v8, v7
  v_add_f32 v8, v8, v7
  v_mul_f32 v8, 0x3ae38e39, v8
  v_cvt_pk_bf16_f32 v8, v8, v6
  v_and_b32 v6, 0xffff0000, v8
  v_lshlrev_b32 v8, 16, v8
  v_add_f32 v8, 0x3727c5ac, v8
  v_cvt_pk_bf16_f32 v8, v8, v8
  v_lshlrev_b32 v8, 16, v8
  v_sqrt_f32 v8, v8
  s_nop 0
  v_cvt_pk_bf16_f32 v8, v8, v8
  v_lshlrev_b32 v8, 16, v8
  v_rcp_f32 v8, v8
  s_nop 0
  v_mul_f32 v6, v6, v8
  v_fma_f32 v20, v20, v8, -v6
  v_fma_f32 v21, v21, v8, -v6
  v_cvt_pk_bf16_f32 v44, v20, v21
  v_fma_f32 v22, v22, v8, -v6
  v_fma_f32 v23, v23, v8, -v6
  v_cvt_pk_bf16_f32 v45, v22, v23
  v_fma_f32 v24, v24, v8, -v6
  v_fma_f32 v25, v25, v8, -v6
  v_cvt_pk_bf16_f32 v46, v24, v25
  v_fma_f32 v26, v26, v8, -v6
  v_fma_f32 v27, v27, v8, -v6
  v_cvt_pk_bf16_f32 v47, v26, v27
  v_fma_f32 v28, v28, v8, -v6
  v_fma_f32 v29, v29, v8, -v6
  v_cvt_pk_bf16_f32 v48, v28, v29
  v_fma_f32 v30, v30, v8, -v6
  v_fma_f32 v31, v31, v8, -v6
  v_cvt_pk_bf16_f32 v49, v30, v31
  v_fma_f32 v32, v32, v8, -v6
  v_fma_f32 v33, v33, v8, -v6
  v_cvt_pk_bf16_f32 v50, v32, v33
  v_fma_f32 v34, v34, v8, -v6
  v_fma_f32 v35, v35, v8, -v6
  v_cvt_pk_bf16_f32 v51, v34, v35
  v_fma_f32 v36, v36, v8, -v6
  v_fma_f32 v37, v37, v8, -v6
  v_cvt_pk_bf16_f32 v52, v36, v37
  v_fma_f32 v38, v38, v8, -v6
  v_fma_f32 v39, v39, v8, -v6
  v_cvt_pk_bf16_f32 v53, v38, v39
  v_fma_f32 v40, v40, v8, -v6
  v_fma_f32 v41, v41, v8, -v6
  v_cvt_pk_bf16_f32 v54, v40, v41
  v_fma_f32 v42, v42, v8, -v6
  v_fma_f32 v43, v43, v8, -v6
  v_cvt_pk_bf16_f32 v55, v42, v43
  s_mov_b32 s20, 12288
  s_mov_b32 s21, 24576
  buffer_store_dwordx4 v[44:47], v4, s[16:19], 0 offen
  buffer_store_dwordx4 v[48:51], v4, s[16:19], s20 offen
  buffer_store_dwordx4 v[52:55], v4, s[16:19], s21 offen
  s_endpgm
C_prep_3:
  s_cmp_ge_u32 s2, 672
  s_cbranch_scc1 E_prep_4
  s_load_dwordx2 s[8:9], s[0:1], 8
  s_sub_u32 s3, s2, 480
  s_and_b32 s6, s3, 7
  s_mul_i32 s6, s6, 24
  s_lshr_b32 s3, s3, 3
  s_add_u32 s3, s3, s6
  s_mul_i32 s6, s3, 43691
  s_lshr_b32 s6, s6, 17
  s_mul_i32 s7, s6, 3
  s_sub_u32 s7, s3, s7
  s_lshr_b32 s10, s6, 1
  s_and_b32 s11, s6, 1
  s_mul_i32 s10, s10, 18
  v_and_b32 v1, 31, v0
  v_bfe_u32 v2, v0, 5, 1
  v_lshrrev_b32 v3, 6, v0
  v_add_u32 v4, 560, v1
  v_cmp_gt_u32 vcc, 16, v1
  s_nop 1
  v_cndmask_b32 v4, v4, v1, vcc
  v_mov_b32 v5, 0x20000000
  v_add_u32 v6, 1152, v1
  v_cmp_gt_u32 vcc, 18, v1
  s_nop 1
  v_cndmask_b32 v5, v5, v6, vcc
  v_lshrrev_b32 v7, 1, v1
  v_subrev_u32 v6, 4, v1
  v_cmp_eq_u32 vcc, 10, v7
  s_nop 1
  v_cndmask_b32 v5, v5, v6, vcc
  v_add_u32 v6, 570, v1
  v_cmp_eq_u32 vcc, 11, v7
  s_nop 1
  v_cndmask_b32 v5, v5, v6, vcc
  s_cmp_eq_u32 s11, 0
  s_cselect_b64 vcc, -1, 0
  v_cndmask_b32 v4, v5, v4, vcc
  v_add_u32 v4, s10, v4
  v_lshlrev_b32 v4, 1, v4
  s_mul_i32 s7, s7, 12
  v_mul_u32_u24 v5, 3, v3
  v_add_u32 v5, s7, v5
  v_lshlrev_b32 v6, 4, v5
  v_lshl_add_u32 v6, v2, 3, v6
  v_mul_u32_u24 v6, 3456, v6
  v_add_u32 v4, v4, v6
  s_mul_i32 s6, s6, 36
  v_add_u32 v5, s6, v5
  v_lshlrev_b32 v5, 10, v5
  v_and_b32 v6, 63, v0
  v_lshl_add_u32 v5, v6, 4, v5
  s_waitcnt lgkmcnt(0)
  s_mov_b32 s12, s8
  s_mov_b32 s13, s9
  s_mov_b32 s14, 0x1e6000
  s_mov_b32 s15, 0x20000
  s_add_u32 s16, s4, 0x266000
  s_addc_u32 s17, s5, 0
  s_mov_b32 s18, 0x240000
  s_mov_b32 s19, 0x20000
  s_mov_b32 s20, 0
  buffer_load_ushort v8, v4, s[12:15], s20 offen
  s_mov_b32 s20, 3456
  buffer_load_ushort v9, v4, s[12:15], s20 offen
  s_mov_b32 s20, 6912
  buffer_load_ushort v10, v4, s[12:15], s20 offen
  s_mov_b32 s20, 10368
  buffer_load_ushort v11, v4, s[12:15], s20 offen
  s_mov_b32 s20, 13824
  buffer_load_ushort v12, v4, s[12:15], s20 offen
  s_mov_b32 s20, 17280
  buffer_load_ushort v13, v4, s[12:15], s20 offen
  s_mov_b32 s20, 20736
  buffer_load_ushort v14, v4, s[12:15], s20 offen
  s_mov_b32 s20, 24192
  buffer_load_ushort v15, v4, s[12:15], s20 offen
  s_mov_b32 s20, 55296
  buffer_load_ushort v16, v4, s[12:15], s20 offen
  s_mov_b32 s20, 58752
  buffer_load_ushort v17, v4, s[12:15], s20 offen
  s_mov_b32 s20, 62208
  buffer_load_ushort v18, v4, s[12:15], s20 offen
  s_mov_b32 s20, 65664
  buffer_load_ushort v19, v4, s[12:15], s20 offen
  s_mov_b32 s20, 69120
  buffer_load_ushort v20, v4, s[12:15], s20 offen
  s_mov_b32 s20, 72576
  buffer_load_ushort v21, v4, s[12:15], s20 offen
  s_mov_b32 s20, 76032
  buffer_load_ushort v22, v4, s[12:15], s20 offen
  s_mov_b32 s20, 79488
  buffer_load_ushort v23, v4, s[12:15], s20 offen
  s_mov_b32 s20, 110592
  buffer_load_ushort v24, v4, s[12:15], s20 offen
  s_mov_b32 s20, 114048
  buffer_load_ushort v25, v4, s[12:15], s20 offen
  s_mov_b32 s20, 117504
  buffer_load_ushort v26, v4, s[12:15], s20 offen
  s_mov_b32 s20, 120960
  buffer_load_ushort v27, v4, s[12:15], s20 offen
  s_mov_b32 s20, 124416
  buffer_load_ushort v28, v4, s[12:15], s20 offen
  s_mov_b32 s20, 127872
  buffer_load_ushort v29, v4, s[12:15], s20 offen
  s_mov_b32 s20, 131328
  buffer_load_ushort v30, v4, s[12:15], s20 offen
  s_mov_b32 s20, 134784
  buffer_load_ushort v31, v4, s[12:15], s20 offen
  s_waitcnt vmcnt(16)
  v_lshl_or_b32 v32, v9, 16, v8
  v_lshl_or_b32 v33, v11, 16, v10
  v_lshl_or_b32 v34, v13, 16, v12
  v_lshl_or_b32 v35, v15, 16, v14
  buffer_store_dwordx4 v[32:35], v5, s[16:19], 0 offen offset:0
  s_waitcnt vmcnt(9)
  v_lshl_or_b32 v36, v17, 16, v16
  v_lshl_or_b32 v37, v19, 16, v18
  v_lshl_or_b32 v38, v21, 16, v20
  v_lshl_or_b32 v39, v23, 16, v22
  buffer_store_dwordx4 v[36:39], v5, s[16:19], 0 offen offset:1024
  s_waitcnt vmcnt(2)
  v_lshl_or_b32 v40, v25, 16, v24
  v_lshl_or_b32 v41, v27, 16, v26
  v_lshl_or_b32 v42, v29, 16, v28
  v_lshl_or_b32 v43, v31, 16, v30
  buffer_store_dwordx4 v[40:43], v5, s[16:19], 0 offen offset:2048
E_prep_4:
  s_endpgm
D_prep_1:
  s_add_u32 s2, s2, 216
  v_lshrrev_b32 v2, 6, v0
  s_nop 0
  v_readfirstlane_b32 s3, v2
  v_and_b32 v2, 63, v0
  v_lshlrev_b32 v2, 4, v2
  s_waitcnt lgkmcnt(0)
  s_mov_b32 s8, s4
  s_mov_b32 s9, s5
  s_mov_b32 s10, 0x2df0000
  s_mov_b32 s11, 0x20000
  s_mov_b32 s40, 0x05040100
  s_mov_b32 s41, 0x07060302
  v_and_b32 v5, 15, v0
  v_bfe_u32 v3, v0, 4, 2
  s_mov_b32 s15, 0x20000
  s_cmp_eq_u32 s3, 0
  s_cbranch_scc1 sent_prep_10
w2_prep_6:
  s_mul_i32 s20, s2, 3
  s_add_u32 s20, s20, s3
  s_sub_u32 s20, s20, 1
  s_cmp_ge_u32 s20, 729
  s_cbranch_scc1 sent_prep_10
  s_cmp_ge_u32 s20, 648
  s_cselect_b32 s21, 648, 0
  s_sub_u32 s21, s20, s21
  s_lshl_b32 s22, s21, 4
  v_add_u32 v7, s22, v5
  v_mul_u32_u24 v8, 58255, v7
  v_lshrrev_b32 v8, 22, v8
  v_mul_u32_u24 v9, 72, v8
  v_sub_u32 v9, v7, v9
  s_mov_b32 s24, 0
  s_mov_b32 s25, 1152
  s_mov_b32 s26, 2304
  s_mov_b32 s27, 3456
  s_cmp_ge_u32 s20, 648
  s_cbranch_scc1 wo_prep_7
  s_load_dwordx2 s[12:13], s[0:1], 40
  s_mov_b32 s14, 5308416
  s_mov_b32 s22, 20840448
  v_and_b32 v10, 0xfc, v8
  v_add_u32 v10, v10, v3
  v_and_b32 v4, 3, v8
  v_lshl_add_u32 v10, v10, 4, v4
  v_mul_u32_u24 v4, 2304, v10
  v_lshl_add_u32 v4, v9, 4, v4
  v_add_u32 v1, 1152, v4
  s_mov_b32 s25, 9216
  s_mov_b32 s26, 18432
  s_mov_b32 s27, 27648
  s_branch q_prep_9
wo_prep_7:
  s_load_dwordx2 s[12:13], s[0:1], 16
  s_mov_b32 s14, 663552
  s_mov_b32 s22, 14573568
  s_cmp_ge_u32 s21, 72
  s_cbranch_scc1 wx_prep_8
  v_lshrrev_b32 v10, 1, v3
  v_lshl_add_u32 v10, v8, 1, v10
  v_mul_u32_u24 v10, 18, v10
  v_and_b32 v12, 1, v3
  v_lshl_add_u32 v10, v12, 2, v10
  v_mul_u32_u24 v4, 1152, v10
  v_lshl_add_u32 v4, v9, 4, v4
  v_add_u32 v1, 9216, v4
  s_branch q_prep_9
wx_prep_8:
  v_subrev_u32 v10, 16, v8
  v_lshlrev_b32 v10, 2, v10
  v_add_u32 v10, v10, v3
  v_mul_u32_u24 v10, 72, v10
  v_add_u32 v10, 16, v10
  v_mul_u32_u24 v4, 1152, v10
  v_lshl_add_u32 v4, v9, 4, v4
  v_add_u32 v1, 41472, v4
  s_mov_b32 s26, 20736
  s_mov_b32 s27, 21888
q_prep_9:
  s_waitcnt lgkmcnt(0)
  buffer_load_dwordx4 v[12:15], v4, s[12:15], s24 offen
  buffer_load_dwordx4 v[16:19], v4, s[12:15], s25 offen
  buffer_load_dwordx4 v[20:23], v4, s[12:15], s26 offen
  buffer_load_dwordx4 v[24:27], v4, s[12:15], s27 offen
  buffer_load_dwordx4 v[28:31], v1, s[12:15], s24 offen
  buffer_load_dwordx4 v[32:35], v1, s[12:15], s25 offen
  buffer_load_dwordx4 v[36:39], v1, s[12:15], s26 offen
  buffer_load_dwordx4 v[40:43], v1, s[12:15], s27 offen
  v_mul_u32_u24 v10, 3641, v8
  v_lshrrev_b32 v10, 16, v10
  v_mul_u32_u24 v10, 608256, v10
  v_mul_u32_u24 v11, 3072, v8
  v_add_u32 v10, v10, v11
  v_mul_u32_u24 v11, 10923, v9
  v_lshrrev_b32 v11, 16, v11
  v_mul_u32_u24 v11, 52224, v11
  v_add_u32 v10, v10, v11
  v_lshrrev_b32 v11, 1, v9
  v_lshl_add_u32 v10, v11, 10, v10
  v_and_b32 v11, 1, v9
  v_lshl_add_u32 v10, v11, 7, v10
  v_lshl_add_u32 v6, v3, 8, v10
  v_and_b32 v44, 56, v0
  v_lshlrev_b32 v44, 2, v44
  ds_bpermute_b32 v68, v44, v6 offset:0
  ds_bpermute_b32 v69, v44, v6 offset:4
  ds_bpermute_b32 v70, v44, v6 offset:8
  ds_bpermute_b32 v71, v44, v6 offset:12
  ds_bpermute_b32 v72, v44, v6 offset:16
  ds_bpermute_b32 v73, v44, v6 offset:20
  ds_bpermute_b32 v74, v44, v6 offset:24
  ds_bpermute_b32 v75, v44, v6 offset:28
  v_and_b32 v44, 0x70, v2
  s_waitcnt lgkmcnt(0)
  v_add_u32 v68, v68, v44
  v_add_u32 v69, v69, v44
  v_add_u32 v70, v70, v44
  v_add_u32 v71, v71, v44
  v_add_u32 v72, v72, v44
  v_add_u32 v73, v73, v44
  v_add_u32 v74, v74, v44
  v_add_u32 v75, v75, v44
  s_waitcnt vmcnt(0)
  v_perm_b32 v44, v16, v12, s40
  v_perm_b32 v45, v24, v20, s40
  v_perm_b32 v46, v32, v28, s40
  v_perm_b32 v47, v40, v36, s40
  v_perm_b32 v48, v16, v12, s41
  v_perm_b32 v49, v24, v20, s41
  v_perm_b32 v50, v32, v28, s41
  v_perm_b32 v51, v40, v36, s41
  v_perm_b32 v52, v17, v13, s40
  v_perm_b32 v53, v25, v21, s40
  v_perm_b32 v54, v33, v29, s40
  v_perm_b32 v55, v41, v37, s40
  v_perm_b32 v56, v17, v13, s41
  v_perm_b32 v57, v25, v21, s41
  v_perm_b32 v58, v33, v29, s41
  v_perm_b32 v59, v41, v37, s41
  s_mov_b32 vcc_lo, 0x55555555
  s_mov_b32 vcc_hi, vcc_lo
  v_cndmask_b32_dpp v12, v48, v44, vcc quad_perm:[1,0,3,2] row_mask:0xf bank_mask:0xf
  v_cndmask_b32_dpp v13, v49, v45, vcc quad_perm:[1,0,3,2] row_mask:0xf bank_mask:0xf
  v_cndmask_b32_dpp v16, v50, v46, vcc quad_perm:[1,0,3,2] row_mask:0xf bank_mask:0xf
  v_cndmask_b32_dpp v17, v51, v47, vcc quad_perm:[1,0,3,2] row_mask:0xf bank_mask:0xf
  v_cndmask_b32_dpp v28, v56, v52, vcc quad_perm:[1,0,3,2] row_mask:0xf bank_mask:0xf
  v_cndmask_b32_dpp v29, v57, v53, vcc quad_perm:[1,0,3,2] row_mask:0xf bank_mask:0xf
  v_cndmask_b32_dpp v32, v58, v54, vcc quad_perm:[1,0,3,2] row_mask:0xf bank_mask:0xf
  v_cndmask_b32_dpp v33, v59, v55, vcc quad_perm:[1,0,3,2] row_mask:0xf bank_mask:0xf
  s_not_b64 vcc, vcc
  v_cndmask_b32_dpp v20, v44, v48, vcc quad_perm:[1,0,3,2] row_mask:0xf bank_mask:0xf
  v_cndmask_b32_dpp v21, v45, v49, vcc quad_perm:[1,0,3,2] row_mask:0xf bank_mask:0xf
  v_cndmask_b32_dpp v24, v46, v50, vcc quad_perm:[1,0,3,2] row_mask:0xf bank_mask:0xf
  v_cndmask_b32_dpp v25, v47, v51, vcc quad_perm:[1,0,3,2] row_mask:0xf bank_mask:0xf
  v_cndmask_b32_dpp v36, v52, v56, vcc quad_perm:[1,0,3,2] row_mask:0xf bank_mask:0xf
  v_cndmask_b32_dpp v37, v53, v57, vcc quad_perm:[1,0,3,2] row_mask:0xf bank_mask:0xf
  v_cndmask_b32_dpp v40, v54, v58, vcc quad_perm:[1,0,3,2] row_mask:0xf bank_mask:0xf
  v_cndmask_b32_dpp v41, v55, v59, vcc quad_perm:[1,0,3,2] row_mask:0xf bank_mask:0xf
  v_perm_b32 v44, v18, v14, s40
  v_perm_b32 v45, v26, v22, s40
  v_perm_b32 v46, v34, v30, s40
  v_perm_b32 v47, v42, v38, s40
  v_perm_b32 v48, v18, v14, s41
  v_perm_b32 v49, v26, v22, s41
  v_perm_b32 v50, v34, v30, s41
  v_perm_b32 v51, v42, v38, s41
  v_perm_b32 v52, v19, v15, s40
  v_perm_b32 v53, v27, v23, s40
  v_perm_b32 v54, v35, v31, s40
  v_perm_b32 v55, v43, v39, s40
  v_perm_b32 v56, v19, v15, s41
  v_perm_b32 v57, v27, v23, s41
  v_perm_b32 v58, v35, v31, s41
  v_perm_b32 v59, v43, v39, s41
  s_mov_b32 vcc_lo, 0x55555555
  s_mov_b32 vcc_hi, vcc_lo
  v_cndmask_b32_dpp v14, v48, v44, vcc quad_perm:[1,0,3,2] row_mask:0xf bank_mask:0xf
  v_cndmask_b32_dpp v15, v49, v45, vcc quad_perm:[1,0,3,2] row_mask:0xf bank_mask:0xf
  v_cndmask_b32_dpp v18, v50, v46, vcc quad_perm:[1,0,3,2] row_mask:0xf bank_mask:0xf
  v_cndmask_b32_dpp v19, v51, v47, vcc quad_perm:[1,0,3,2] row_mask:0xf bank_mask:0xf
  v_cndmask_b32_dpp v30, v56, v52, vcc quad_perm:[1,0,3,2] row_mask:0xf bank_mask:0xf
  v_cndmask_b32_dpp v31, v57, v53, vcc quad_perm:[1,0,3,2] row_mask:0xf bank_mask:0xf
  v_cndmask_b32_dpp v34, v58, v54, vcc quad_perm:[1,0,3,2] row_mask:0xf bank_mask:0xf
  v_cndmask_b32_dpp v35, v59, v55, vcc quad_perm:[1,0,3,2] row_mask:0xf bank_mask:0xf
  s_not_b64 vcc, vcc
  v_cndmask_b32_dpp v22, v44, v48, vcc quad_perm:[1,0,3,2] row_mask:0xf bank_mask:0xf
  v_cndmask_b32_dpp v23, v45, v49, vcc quad_perm:[1,0,3,2] row_mask:0xf bank_mask:0xf
  v_cndmask_b32_dpp v26, v46, v50, vcc quad_perm:[1,0,3,2] row_mask:0xf bank_mask:0xf
  v_cndmask_b32_dpp v27, v47, v51, vcc quad_perm:[1,0,3,2] row_mask:0xf bank_mask:0xf
  v_cndmask_b32_dpp v38, v52, v56, vcc quad_perm:[1,0,3,2] row_mask:0xf bank_mask:0xf
  v_cndmask_b32_dpp v39, v53, v57, vcc quad_perm:[1,0,3,2] row_mask:0xf bank_mask:0xf
  v_cndmask_b32_dpp v42, v54, v58, vcc quad_perm:[1,0,3,2] row_mask:0xf bank_mask:0xf
  v_cndmask_b32_dpp v43, v55, v59, vcc quad_perm:[1,0,3,2] row_mask:0xf bank_mask:0xf
  s_mov_b32 vcc_lo, 0x33333333
  s_mov_b32 vcc_hi, vcc_lo
  v_cndmask_b32_dpp v44, v28, v12, vcc quad_perm:[2,3,0,1] row_mask:0xf bank_mask:0xf
  v_cndmask_b32_dpp v45, v29, v13, vcc quad_perm:[2,3,0,1] row_mask:0xf bank_mask:0xf
  v_cndmask_b32_dpp v46, v32, v16, vcc quad_perm:[2,3,0,1] row_mask:0xf bank_mask:0xf
  v_cndmask_b32_dpp v47, v33, v17, vcc quad_perm:[2,3,0,1] row_mask:0xf bank_mask:0xf
  v_cndmask_b32_dpp v48, v36, v20, vcc quad_perm:[2,3,0,1] row_mask:0xf bank_mask:0xf
  v_cndmask_b32_dpp v49, v37, v21, vcc quad_perm:[2,3,0,1] row_mask:0xf bank_mask:0xf
  v_cndmask_b32_dpp v50, v40, v24, vcc quad_perm:[2,3,0,1] row_mask:0xf bank_mask:0xf
  v_cndmask_b32_dpp v51, v41, v25, vcc quad_perm:[2,3,0,1] row_mask:0xf bank_mask:0xf
  v_cndmask_b32_dpp v52, v30, v14, vcc quad_perm:[2,3,0,1] row_mask:0xf bank_mask:0xf
  v_cndmask_b32_dpp v53, v31, v15, vcc quad_perm:[2,3,0,1] row_mask:0xf bank_mask:0xf
  v_cndmask_b32_dpp v54, v34, v18, vcc quad_perm:[2,3,0,1] row_mask:0xf bank_mask:0xf
  v_cndmask_b32_dpp v55, v35, v19, vcc quad_perm:[2,3,0,1] row_mask:0xf bank_mask:0xf
  v_cndmask_b32_dpp v56, v38, v22, vcc quad_perm:[2,3,0,1] row_mask:0xf bank_mask:0xf
  v_cndmask_b32_dpp v57, v39, v23, vcc quad_perm:[2,3,0,1] row_mask:0xf bank_mask:0xf
  v_cndmask_b32_dpp v58, v42, v26, vcc quad_perm:[2,3,0,1] row_mask:0xf bank_mask:0xf
  v_cndmask_b32_dpp v59, v43, v27, vcc quad_perm:[2,3,0,1] row_mask:0xf bank_mask:0xf
  s_not_b64 vcc, vcc
  v_cndmask_b32_dpp v28, v12, v28, vcc quad_perm:[2,3,0,1] row_mask:0xf bank_mask:0xf
  v_cndmask_b32_dpp v29, v13, v29, vcc quad_perm:[2,3,0,1] row_mask:0xf bank_mask:0xf
  v_cndmask_b32_dpp v32, v16, v32, vcc quad_perm:[2,3,0,1] row_mask:0xf bank_mask:0xf
  v_cndmask_b32_dpp v33, v17, v33, vcc quad_perm:[2,3,0,1] row_mask:0xf bank_mask:0xf
  v_cndmask_b32_dpp v36, v20, v36, vcc quad_perm:[2,3,0,1] row_mask:0xf bank_mask:0xf
  v_cndmask_b32_dpp v37, v21, v37, vcc quad_perm:[2,3,0,1] row_mask:0xf bank_mask:0xf
  v_cndmask_b32_dpp v40, v24, v40, vcc quad_perm:[2,3,0,1] row_mask:0xf bank_mask:0xf
  v_cndmask_b32_dpp v41, v25, v41, vcc quad_perm:[2,3,0,1] row_mask:0xf bank_mask:0xf
  v_cndmask_b32_dpp v30, v14, v30, vcc quad_perm:[2,3,0,1] row_mask:0xf bank_mask:0xf
  v_cndmask_b32_dpp v31, v15, v31, vcc quad_perm:[2,3,0,1] row_mask:0xf bank_mask:0xf
  v_cndmask_b32_dpp v34, v18, v34, vcc quad_perm:[2,3,0,1] row_mask:0xf bank_mask:0xf
  v_cndmask_b32_dpp v35, v19, v35, vcc quad_perm:[2,3,0,1] row_mask:0xf bank_mask:0xf
  v_cndmask_b32_dpp v38, v22, v38, vcc quad_perm:[2,3,0,1] row_mask:0xf bank_mask:0xf
  v_cndmask_b32_dpp v39, v23, v39, vcc quad_perm:[2,3,0,1] row_mask:0xf bank_mask:0xf
  v_cndmask_b32_dpp v42, v26, v42, vcc quad_perm:[2,3,0,1] row_mask:0xf bank_mask:0xf
  v_cndmask_b32_dpp v43, v27, v43, vcc quad_perm:[2,3,0,1] row_mask:0xf bank_mask:0xf
  s_mov_b32 vcc_lo, 0xf0f0f0f
  s_mov_b32 vcc_hi, vcc_lo
  v_cndmask_b32_dpp v12, v30, v28, vcc row_ror:4 row_mask:0xf bank_mask:0xf
  v_cndmask_b32_dpp v13, v31, v29, vcc row_ror:4 row_mask:0xf bank_mask:0xf
  v_cndmask_b32_dpp v14, v34, v32, vcc row_ror:4 row_mask:0xf bank_mask:0xf
  v_cndmask_b32_dpp v15, v35, v33, vcc row_ror:4 row_mask:0xf bank_mask:0xf
  v_cndmask_b32_dpp v20, v38, v36, vcc row_ror:4 row_mask:0xf bank_mask:0xf
  v_cndmask_b32_dpp v21, v39, v37, vcc row_ror:4 row_mask:0xf bank_mask:0xf
  v_cndmask_b32_dpp v22, v42, v40, vcc row_ror:4 row_mask:0xf bank_mask:0xf
  v_cndmask_b32_dpp v23, v43, v41, vcc row_ror:4 row_mask:0xf bank_mask:0xf
  s_not_b64 vcc, vcc
  v_cndmask_b32_dpp v16, v28, v30, vcc row_ror:12 row_mask:0xf bank_mask:0xf
  v_cndmask_b32_dpp v17, v29, v31, vcc row_ror:12 row_mask:0xf bank_mask:0xf
  v_cndmask_b32_dpp v18, v32, v34, vcc row_ror:12 row_mask:0xf bank_mask:0xf
  v_cndmask_b32_dpp v19, v33, v35, vcc row_ror:12 row_mask:0xf bank_mask:0xf
  v_cndmask_b32_dpp v24, v36, v38, vcc row_ror:12 row_mask:0xf bank_mask:0xf
  v_cndmask_b32_dpp v25, v37, v39, vcc row_ror:12 row_mask:0xf bank_mask:0xf
  v_cndmask_b32_dpp v26, v40, v42, vcc row_ror:12 row_mask:0xf bank_mask:0xf
  v_cndmask_b32_dpp v27, v41, v43, vcc row_ror:12 row_mask:0xf bank_mask:0xf
  buffer_store_dwordx4 v[12:15], v70, s[8:11], s22 offen sc1
  buffer_store_dwordx4 v[16:19], v74, s[8:11], s22 offen sc1
  buffer_store_dwordx4 v[20:23], v71, s[8:11], s22 offen sc1
  buffer_store_dwordx4 v[24:27], v75, s[8:11], s22 offen sc1
  s_mov_b32 vcc_lo, 0xf0f0f0f
  s_mov_b32 vcc_hi, vcc_lo
  v_cndmask_b32_dpp v28, v52, v44, vcc row_ror:4 row_mask:0xf bank_mask:0xf
  v_cndmask_b32_dpp v29, v53, v45, vcc row_ror:4 row_mask:0xf bank_mask:0xf
  v_cndmask_b32_dpp v30, v54, v46, vcc row_ror:4 row_mask:0xf bank_mask:0xf
  v_cndmask_b32_dpp v31, v55, v47, vcc row_ror:4 row_mask:0xf bank_mask:0xf
  v_cndmask_b32_dpp v36, v56, v48, vcc row_ror:4 row_mask:0xf bank_mask:0xf
  v_cndmask_b32_dpp v37, v57, v49, vcc row_ror:4 row_mask:0xf bank_mask:0xf
  v_cndmask_b32_dpp v38, v58, v50, vcc row_ror:4 row_mask:0xf bank_mask:0xf
  v_cndmask_b32_dpp v39, v59, v51, vcc row_ror:4 row_mask:0xf bank_mask:0xf
  s_not_b64 vcc, vcc
  v_cndmask_b32_dpp v32, v44, v52, vcc row_ror:12 row_mask:0xf bank_mask:0xf
  v_cndmask_b32_dpp v33, v45, v53, vcc row_ror:12 row_mask:0xf bank_mask:0xf
  v_cndmask_b32_dpp v34, v46, v54, vcc row_ror:12 row_mask:0xf bank_mask:0xf
  v_cndmask_b32_dpp v35, v47, v55, vcc row_ror:12 row_mask:0xf bank_mask:0xf
  v_cndmask_b32_dpp v40, v48, v56, vcc row_ror:12 row_mask:0xf bank_mask:0xf
  v_cndmask_b32_dpp v41, v49, v57, vcc row_ror:12 row_mask:0xf bank_mask:0xf
  v_cndmask_b32_dpp v42, v50, v58, vcc row_ror:12 row_mask:0xf bank_mask:0xf
  v_cndmask_b32_dpp v43, v51, v59, vcc row_ror:12 row_mask:0xf bank_mask:0xf
  buffer_store_dwordx4 v[28:31], v68, s[8:11], s22 offen sc1
  buffer_store_dwordx4 v[32:35], v72, s[8:11], s22 offen sc1
  buffer_store_dwordx4 v[36:39], v69, s[8:11], s22 offen sc1
  buffer_store_dwordx4 v[40:43], v73, s[8:11], s22 offen sc1
  s_waitcnt vmcnt(0)
sent_prep_10:
  s_endpgm
.text
.globl main_kernel
.p2align 8
.type main_kernel,@function
main_kernel:
  s_cmp_ge_u32 s2, 256
  s_cbranch_scc1 E_main_1
  s_load_dwordx2 s[4:5], s[0:1], 80
  v_lshrrev_b32 v2, 6, v0
  s_nop 0
  v_readfirstlane_b32 s3, v2
  v_and_b32 v1, 63, v0
  v_lshlrev_b32 v2, 4, v1
  v_bfe_u32 v3, v0, 5, 1
  v_and_b32 v4, 31, v0
  s_and_b32 s6, s2, 3
  s_lshl_b32 s6, s6, 3
  s_bfe_u32 s12, s2, 0x30003
  s_add_u32 s6, s6, s12
  s_lshr_b32 s13, s2, 6
  s_and_b32 s7, s2, 4
  s_add_u32 s7, s7, s13
  s_cmp_ge_u32 s3, 4
  s_cbranch_scc1 C_main_2
  s_setprio 3
  v_and_b32 v5, 60, v1
  v_subrev_u32 v6, 36, v1
  v_and_b32 v6, 30, v6
  v_lshlrev_b32 v6, 1, v6
  v_cmp_gt_u32 vcc, 36, v1
  s_nop 1
  v_cndmask_b32 v5, v6, v5, vcc
  v_add_u32 v5, s3, v5
  v_and_b32 v6, 48, v2
  v_lshl_add_u32 v6, v5, 6, v6
  v_add_u32 v6, 2304, v6
  v_and_b32 v7, 16, v2
  v_lshl_add_u32 v7, v5, 5, v7
  v_add_u32 v7, 16384, v7
  v_cndmask_b32 v5, v7, v6, vcc
  v_bfrev_b32 v6, 1
  v_add_u32 v7, 36864, v2
  v_cmp_gt_u32 vcc, 24, v4
  s_nop 1
  v_cndmask_b32 v153, v6, v7, vcc
  s_mul_i32 s14, s6, 73728
  s_add_u32 s14, s14, 2514944
  s_lshl_b32 s18, s3, 10
  s_add_u32 s13, s18, s14
  s_add_u32 s18, s18, 19456
  s_mov_b32 m0, s18
  s_mov_b32 exec_hi, 0x3fffff
  s_waitcnt lgkmcnt(0)
  s_mov_b32 s8, s4
  s_mov_b32 s9, s5
  s_mov_b32 s10, 0x2df0000
  s_mov_b32 s11, 0x20000
  buffer_load_dwordx4 v5, s[8:11], 0 offen lds
  s_mov_b32 exec_hi, -1
  buffer_load_dwordx4 v[40:43], v2, s[8:11], s13 offen
  buffer_load_dwordx4 v[44:47], v153, s[8:11], s13 offen
  s_add_u32 s13, s13, 4096
  buffer_load_dwordx4 v[48:51], v2, s[8:11], s13 offen
  buffer_load_dwordx4 v[52:55], v153, s[8:11], s13 offen
  s_add_u32 s13, s13, 4096
  s_barrier
  buffer_load_dwordx4 v[56:59], v2, s[8:11], s13 offen
  buffer_load_dwordx4 v[60:63], v153, s[8:11], s13 offen
  s_add_u32 s13, s13, 4096
  v_mov_b32 v136, 0
  v_mov_b32 v137, 0
  v_mov_b32 v138, 158720
  ds_write_b64 v138, v[136:137]
  v_lshlrev_b32 v139, 2, v4
  v_add_u32 v139, 158784, v139
  v_mov_b32 v140, 0x01010101
  s_mov_b32 vcc_lo, 0x180
  s_mov_b32 vcc_hi, vcc_lo
  v_cndmask_b32 v140, 0, v140, vcc
  ds_write_b32 v139, v140
  v_lshl_add_u32 v5, v3, 5, s18
  v_lshl_add_u32 v6, v3, 4, s18
  s_lshl_b32 s19, s3, 11
  s_add_u32 s19, s19, 77824
  v_add_u32 v7, s19, v2
  s_waitcnt vmcnt(6)
  ds_read_b128 v[112:115], v5 offset:0
  ds_read_b128 v[116:119], v5 offset:16
  ds_read_b128 v[120:123], v6 offset:576
  ds_read_b128 v[124:127], v5 offset:64
  ds_read_b128 v[128:131], v5 offset:80
  ds_read_b128 v[132:135], v6 offset:608
  s_waitcnt vmcnt(4) lgkmcnt(3)
  v_mfma_f32_32x32x16_bf16 v[8:23], v[120:123], v[40:43], 0
  v_lshlrev_b32 v136, 16, v40
  v_and_b32 v137, 0xffff0000, v40
  v_lshlrev_b32 v138, 16, v41
  v_and_b32 v139, 0xffff0000, v41
  v_lshlrev_b32 v140, 16, v42
  v_and_b32 v141, 0xffff0000, v42
  v_lshlrev_b32 v142, 16, v43
  v_and_b32 v143, 0xffff0000, v43
  v_mul_f32 v136, v136, v112
  v_mul_f32 v137, v137, v113
  v_mul_f32 v138, v138, v114
  v_mul_f32 v139, v139, v115
  v_mul_f32 v140, v140, v116
  v_mul_f32 v141, v141, v117
  v_mul_f32 v142, v142, v118
  v_mul_f32 v143, v143, v119
  v_cvt_pk_bf16_f32 v136, v136, v137
  v_cvt_pk_bf16_f32 v137, v138, v139
  v_cvt_pk_bf16_f32 v138, v140, v141
  v_cvt_pk_bf16_f32 v139, v142, v143
  ds_write_b128 v7, v[136:139] offset:0
  v_mfma_f32_32x32x16_bf16 v[24:39], v[120:123], v[44:47], 0
  v_lshlrev_b32 v144, 16, v44
  v_and_b32 v145, 0xffff0000, v44
  v_lshlrev_b32 v146, 16, v45
  v_and_b32 v147, 0xffff0000, v45
  v_lshlrev_b32 v148, 16, v46
  v_and_b32 v149, 0xffff0000, v46
  v_lshlrev_b32 v150, 16, v47
  v_and_b32 v151, 0xffff0000, v47
  v_mul_f32 v144, v144, v112
  v_mul_f32 v145, v145, v113
  v_mul_f32 v146, v146, v114
  v_mul_f32 v147, v147, v115
  v_mul_f32 v148, v148, v116
  v_mul_f32 v149, v149, v117
  v_mul_f32 v150, v150, v118
  v_mul_f32 v151, v151, v119
  v_cvt_pk_bf16_f32 v144, v144, v145
  v_cvt_pk_bf16_f32 v145, v146, v147
  v_cvt_pk_bf16_f32 v146, v148, v149
  v_cvt_pk_bf16_f32 v147, v150, v151
  ds_write_b128 v7, v[144:147] offset:1024
  s_waitcnt lgkmcnt(0)
  s_barrier
  buffer_load_dwordx4 v[64:67], v2, s[8:11], s13 offen
  buffer_load_dwordx4 v[68:71], v153, s[8:11], s13 offen
  s_add_u32 s13, s13, 4096
  ds_read_b128 v[112:115], v5 offset:128
  ds_read_b128 v[116:119], v5 offset:144
  ds_read_b128 v[120:123], v6 offset:640
  s_waitcnt vmcnt(4) lgkmcnt(3)
  v_mfma_f32_32x32x16_bf16 v[8:23], v[132:135], v[48:51], v[8:23]
  v_lshlrev_b32 v136, 16, v48
  v_and_b32 v137, 0xffff0000, v48
  v_lshlrev_b32 v138, 16, v49
  v_and_b32 v139, 0xffff0000, v49
  v_lshlrev_b32 v140, 16, v50
  v_and_b32 v141, 0xffff0000, v50
  v_lshlrev_b32 v142, 16, v51
  v_and_b32 v143, 0xffff0000, v51
  v_mul_f32 v136, v136, v124
  v_mul_f32 v137, v137, v125
  v_mul_f32 v138, v138, v126
  v_mul_f32 v139, v139, v127
  v_mul_f32 v140, v140, v128
  v_mul_f32 v141, v141, v129
  v_mul_f32 v142, v142, v130
  v_mul_f32 v143, v143, v131
  v_cvt_pk_bf16_f32 v136, v136, v137
  v_cvt_pk_bf16_f32 v137, v138, v139
  v_cvt_pk_bf16_f32 v138, v140, v141
  v_cvt_pk_bf16_f32 v139, v142, v143
  ds_write_b128 v7, v[136:139] offset:8192
  v_mfma_f32_32x32x16_bf16 v[24:39], v[132:135], v[52:55], v[24:39]
  v_lshlrev_b32 v144, 16, v52
  v_and_b32 v145, 0xffff0000, v52
  v_lshlrev_b32 v146, 16, v53
  v_and_b32 v147, 0xffff0000, v53
  v_lshlrev_b32 v148, 16, v54
  v_and_b32 v149, 0xffff0000, v54
  v_lshlrev_b32 v150, 16, v55
  v_and_b32 v151, 0xffff0000, v55
  v_mul_f32 v144, v144, v124
  v_mul_f32 v145, v145, v125
  v_mul_f32 v146, v146, v126
  v_mul_f32 v147, v147, v127
  v_mul_f32 v148, v148, v128
  v_mul_f32 v149, v149, v129
  v_mul_f32 v150, v150, v130
  v_mul_f32 v151, v151, v131
  v_cvt_pk_bf16_f32 v144, v144, v145
  v_cvt_pk_bf16_f32 v145, v146, v147
  v_cvt_pk_bf16_f32 v146, v148, v149
  v_cvt_pk_bf16_f32 v147, v150, v151
  ds_write_b128 v7, v[144:147] offset:9216
  s_waitcnt lgkmcnt(0)
  s_barrier
  buffer_load_dwordx4 v[72:75], v2, s[8:11], s13 offen
  buffer_load_dwordx4 v[76:79], v153, s[8:11], s13 offen
  s_add_u32 s13, s13, 4096
  ds_read_b128 v[124:127], v5 offset:192
  ds_read_b128 v[128:131], v5 offset:208
  ds_read_b128 v[132:135], v6 offset:672
  s_waitcnt vmcnt(4) lgkmcnt(3)
  v_mfma_f32_32x32x16_bf16 v[8:23], v[120:123], v[56:59], v[8:23]
  v_lshlrev_b32 v136, 16, v56
  v_and_b32 v137, 0xffff0000, v56
  v_lshlrev_b32 v138, 16, v57
  v_and_b32 v139, 0xffff0000, v57
  v_lshlrev_b32 v140, 16, v58
  v_and_b32 v141, 0xffff0000, v58
  v_lshlrev_b32 v142, 16, v59
  v_and_b32 v143, 0xffff0000, v59
  v_mul_f32 v136, v136, v112
  v_mul_f32 v137, v137, v113
  v_mul_f32 v138, v138, v114
  v_mul_f32 v139, v139, v115
  v_mul_f32 v140, v140, v116
  v_mul_f32 v141, v141, v117
  v_mul_f32 v142, v142, v118
  v_mul_f32 v143, v143, v119
  v_cvt_pk_bf16_f32 v136, v136, v137
  v_cvt_pk_bf16_f32 v137, v138, v139
  v_cvt_pk_bf16_f32 v138, v140, v141
  v_cvt_pk_bf16_f32 v139, v142, v143
  ds_write_b128 v7, v[136:139] offset:16384
  v_mfma_f32_32x32x16_bf16 v[24:39], v[120:123], v[60:63], v[24:39]
  v_lshlrev_b32 v144, 16, v60
  v_and_b32 v145, 0xffff0000, v60
  v_lshlrev_b32 v146, 16, v61
  v_and_b32 v147, 0xffff0000, v61
  v_lshlrev_b32 v148, 16, v62
  v_and_b32 v149, 0xffff0000, v62
  v_lshlrev_b32 v150, 16, v63
  v_and_b32 v151, 0xffff0000, v63
  v_mul_f32 v144, v144, v112
  v_mul_f32 v145, v145, v113
  v_mul_f32 v146, v146, v114
  v_mul_f32 v147, v147, v115
  v_mul_f32 v148, v148, v116
  v_mul_f32 v149, v149, v117
  v_mul_f32 v150, v150, v118
  v_mul_f32 v151, v151, v119
  v_cvt_pk_bf16_f32 v144, v144, v145
  v_cvt_pk_bf16_f32 v145, v146, v147
  v_cvt_pk_bf16_f32 v146, v148, v149
  v_cvt_pk_bf16_f32 v147, v150, v151
  ds_write_b128 v7, v[144:147] offset:17408
  buffer_load_dwordx4 v[80:83], v2, s[8:11], s13 offen
  buffer_load_dwordx4 v[84:87], v153, s[8:11], s13 offen
  s_add_u32 s13, s13, 4096
  ds_read_b128 v[112:115], v5 offset:256
  ds_read_b128 v[116:119], v5 offset:272
  ds_read_b128 v[120:123], v6 offset:704
  s_waitcnt vmcnt(4) lgkmcnt(5)
  v_mfma_f32_32x32x16_bf16 v[8:23], v[132:135], v[64:67], v[8:23]
  v_lshlrev_b32 v136, 16, v64
  v_and_b32 v137, 0xffff0000, v64
  v_lshlrev_b32 v138, 16, v65
  v_and_b32 v139, 0xffff0000, v65
  v_lshlrev_b32 v140, 16, v66
  v_and_b32 v141, 0xffff0000, v66
  v_lshlrev_b32 v142, 16, v67
  v_and_b32 v143, 0xffff0000, v67
  v_mul_f32 v136, v136, v124
  v_mul_f32 v137, v137, v125
  v_mul_f32 v138, v138, v126
  v_mul_f32 v139, v139, v127
  v_mul_f32 v140, v140, v128
  v_mul_f32 v141, v141, v129
  v_mul_f32 v142, v142, v130
  v_mul_f32 v143, v143, v131
  v_cvt_pk_bf16_f32 v136, v136, v137
  v_cvt_pk_bf16_f32 v137, v138, v139
  v_cvt_pk_bf16_f32 v138, v140, v141
  v_cvt_pk_bf16_f32 v139, v142, v143
  ds_write_b128 v7, v[136:139] offset:24576
  v_mfma_f32_32x32x16_bf16 v[24:39], v[132:135], v[68:71], v[24:39]
  v_lshlrev_b32 v144, 16, v68
  v_and_b32 v145, 0xffff0000, v68
  v_lshlrev_b32 v146, 16, v69
  v_and_b32 v147, 0xffff0000, v69
  v_lshlrev_b32 v148, 16, v70
  v_and_b32 v149, 0xffff0000, v70
  v_lshlrev_b32 v150, 16, v71
  v_and_b32 v151, 0xffff0000, v71
  v_mul_f32 v144, v144, v124
  v_mul_f32 v145, v145, v125
  v_mul_f32 v146, v146, v126
  v_mul_f32 v147, v147, v127
  v_mul_f32 v148, v148, v128
  v_mul_f32 v149, v149, v129
  v_mul_f32 v150, v150, v130
  v_mul_f32 v151, v151, v131
  v_cvt_pk_bf16_f32 v144, v144, v145
  v_cvt_pk_bf16_f32 v145, v146, v147
  v_cvt_pk_bf16_f32 v146, v148, v149
  v_cvt_pk_bf16_f32 v147, v150, v151
  ds_write_b128 v7, v[144:147] offset:25600
  s_waitcnt lgkmcnt(0)
  s_barrier
  buffer_load_dwordx4 v[88:91], v2, s[8:11], s13 offen
  buffer_load_dwordx4 v[92:95], v153, s[8:11], s13 offen
  s_add_u32 s13, s13, 4096
  ds_read_b128 v[124:127], v5 offset:320
  ds_read_b128 v[128:131], v5 offset:336
  ds_read_b128 v[132:135], v6 offset:736
  s_waitcnt vmcnt(4) lgkmcnt(3)
  v_mfma_f32_32x32x16_bf16 v[8:23], v[120:123], v[72:75], v[8:23]
  v_lshlrev_b32 v136, 16, v72
  v_and_b32 v137, 0xffff0000, v72
  v_lshlrev_b32 v138, 16, v73
  v_and_b32 v139, 0xffff0000, v73
  v_lshlrev_b32 v140, 16, v74
  v_and_b32 v141, 0xffff0000, v74
  v_lshlrev_b32 v142, 16, v75
  v_and_b32 v143, 0xffff0000, v75
  v_mul_f32 v136, v136, v112
  v_mul_f32 v137, v137, v113
  v_mul_f32 v138, v138, v114
  v_mul_f32 v139, v139, v115
  v_mul_f32 v140, v140, v116
  v_mul_f32 v141, v141, v117
  v_mul_f32 v142, v142, v118
  v_mul_f32 v143, v143, v119
  v_cvt_pk_bf16_f32 v136, v136, v137
  v_cvt_pk_bf16_f32 v137, v138, v139
  v_cvt_pk_bf16_f32 v138, v140, v141
  v_cvt_pk_bf16_f32 v139, v142, v143
  ds_write_b128 v7, v[136:139] offset:32768
  v_mfma_f32_32x32x16_bf16 v[24:39], v[120:123], v[76:79], v[24:39]
  v_lshlrev_b32 v144, 16, v76
  v_and_b32 v145, 0xffff0000, v76
  v_lshlrev_b32 v146, 16, v77
  v_and_b32 v147, 0xffff0000, v77
  v_lshlrev_b32 v148, 16, v78
  v_and_b32 v149, 0xffff0000, v78
  v_lshlrev_b32 v150, 16, v79
  v_and_b32 v151, 0xffff0000, v79
  v_mul_f32 v144, v144, v112
  v_mul_f32 v145, v145, v113
  v_mul_f32 v146, v146, v114
  v_mul_f32 v147, v147, v115
  v_mul_f32 v148, v148, v116
  v_mul_f32 v149, v149, v117
  v_mul_f32 v150, v150, v118
  v_mul_f32 v151, v151, v119
  v_cvt_pk_bf16_f32 v144, v144, v145
  v_cvt_pk_bf16_f32 v145, v146, v147
  v_cvt_pk_bf16_f32 v146, v148, v149
  v_cvt_pk_bf16_f32 v147, v150, v151
  ds_write_b128 v7, v[144:147] offset:33792
  buffer_load_dwordx4 v[96:99], v2, s[8:11], s13 offen
  buffer_load_dwordx4 v[100:103], v153, s[8:11], s13 offen
  s_add_u32 s13, s13, 4096
  ds_read_b128 v[112:115], v5 offset:384
  ds_read_b128 v[116:119], v5 offset:400
  ds_read_b128 v[120:123], v6 offset:768
  s_waitcnt vmcnt(4) lgkmcnt(5)
  v_mfma_f32_32x32x16_bf16 v[8:23], v[132:135], v[80:83], v[8:23]
  v_lshlrev_b32 v136, 16, v80
  v_and_b32 v137, 0xffff0000, v80
  v_lshlrev_b32 v138, 16, v81
  v_and_b32 v139, 0xffff0000, v81
  v_lshlrev_b32 v140, 16, v82
  v_and_b32 v141, 0xffff0000, v82
  v_lshlrev_b32 v142, 16, v83
  v_and_b32 v143, 0xffff0000, v83
  v_mul_f32 v136, v136, v124
  v_mul_f32 v137, v137, v125
  v_mul_f32 v138, v138, v126
  v_mul_f32 v139, v139, v127
  v_mul_f32 v140, v140, v128
  v_mul_f32 v141, v141, v129
  v_mul_f32 v142, v142, v130
  v_mul_f32 v143, v143, v131
  v_cvt_pk_bf16_f32 v136, v136, v137
  v_cvt_pk_bf16_f32 v137, v138, v139
  v_cvt_pk_bf16_f32 v138, v140, v141
  v_cvt_pk_bf16_f32 v139, v142, v143
  ds_write_b128 v7, v[136:139] offset:40960
  v_mfma_f32_32x32x16_bf16 v[24:39], v[132:135], v[84:87], v[24:39]
  v_lshlrev_b32 v144, 16, v84
  v_and_b32 v145, 0xffff0000, v84
  v_lshlrev_b32 v146, 16, v85
  v_and_b32 v147, 0xffff0000, v85
  v_lshlrev_b32 v148, 16, v86
  v_and_b32 v149, 0xffff0000, v86
  v_lshlrev_b32 v150, 16, v87
  v_and_b32 v151, 0xffff0000, v87
  v_mul_f32 v144, v144, v124
  v_mul_f32 v145, v145, v125
  v_mul_f32 v146, v146, v126
  v_mul_f32 v147, v147, v127
  v_mul_f32 v148, v148, v128
  v_mul_f32 v149, v149, v129
  v_mul_f32 v150, v150, v130
  v_mul_f32 v151, v151, v131
  v_cvt_pk_bf16_f32 v144, v144, v145
  v_cvt_pk_bf16_f32 v145, v146, v147
  v_cvt_pk_bf16_f32 v146, v148, v149
  v_cvt_pk_bf16_f32 v147, v150, v151
  ds_write_b128 v7, v[144:147] offset:41984
  s_waitcnt lgkmcnt(0)
  s_barrier
  buffer_load_dwordx4 v[104:107], v2, s[8:11], s13 offen
  buffer_load_dwordx4 v[108:111], v153, s[8:11], s13 offen
  ds_read_b128 v[124:127], v5 offset:448
  ds_read_b128 v[128:131], v5 offset:464
  ds_read_b128 v[132:135], v6 offset:800
  s_waitcnt vmcnt(4) lgkmcnt(3)
  v_mfma_f32_32x32x16_bf16 v[8:23], v[120:123], v[88:91], v[8:23]
  v_lshlrev_b32 v136, 16, v88
  v_and_b32 v137, 0xffff0000, v88
  v_lshlrev_b32 v138, 16, v89
  v_and_b32 v139, 0xffff0000, v89
  v_lshlrev_b32 v140, 16, v90
  v_and_b32 v141, 0xffff0000, v90
  v_lshlrev_b32 v142, 16, v91
  v_and_b32 v143, 0xffff0000, v91
  v_mul_f32 v136, v136, v112
  v_mul_f32 v137, v137, v113
  v_mul_f32 v138, v138, v114
  v_mul_f32 v139, v139, v115
  v_mul_f32 v140, v140, v116
  v_mul_f32 v141, v141, v117
  v_mul_f32 v142, v142, v118
  v_mul_f32 v143, v143, v119
  v_cvt_pk_bf16_f32 v136, v136, v137
  v_cvt_pk_bf16_f32 v137, v138, v139
  v_cvt_pk_bf16_f32 v138, v140, v141
  v_cvt_pk_bf16_f32 v139, v142, v143
  ds_write_b128 v7, v[136:139] offset:49152
  v_mfma_f32_32x32x16_bf16 v[24:39], v[120:123], v[92:95], v[24:39]
  v_lshlrev_b32 v144, 16, v92
  v_and_b32 v145, 0xffff0000, v92
  v_lshlrev_b32 v146, 16, v93
  v_and_b32 v147, 0xffff0000, v93
  v_lshlrev_b32 v148, 16, v94
  v_and_b32 v149, 0xffff0000, v94
  v_lshlrev_b32 v150, 16, v95
  v_and_b32 v151, 0xffff0000, v95
  v_mul_f32 v144, v144, v112
  v_mul_f32 v145, v145, v113
  v_mul_f32 v146, v146, v114
  v_mul_f32 v147, v147, v115
  v_mul_f32 v148, v148, v116
  v_mul_f32 v149, v149, v117
  v_mul_f32 v150, v150, v118
  v_mul_f32 v151, v151, v119
  v_cvt_pk_bf16_f32 v144, v144, v145
  v_cvt_pk_bf16_f32 v145, v146, v147
  v_cvt_pk_bf16_f32 v146, v148, v149
  v_cvt_pk_bf16_f32 v147, v150, v151
  ds_write_b128 v7, v[144:147] offset:50176
  ds_read_b128 v[112:115], v5 offset:512
  ds_read_b128 v[116:119], v5 offset:528
  ds_read_b128 v[120:123], v6 offset:832
  s_waitcnt vmcnt(2) lgkmcnt(5)
  v_mfma_f32_32x32x16_bf16 v[8:23], v[132:135], v[96:99], v[8:23]
  v_lshlrev_b32 v136, 16, v96
  v_and_b32 v137, 0xffff0000, v96
  v_lshlrev_b32 v138, 16, v97
  v_and_b32 v139, 0xffff0000, v97
  v_lshlrev_b32 v140, 16, v98
  v_and_b32 v141, 0xffff0000, v98
  v_lshlrev_b32 v142, 16, v99
  v_and_b32 v143, 0xffff0000, v99
  v_mul_f32 v136, v136, v124
  v_mul_f32 v137, v137, v125
  v_mul_f32 v138, v138, v126
  v_mul_f32 v139, v139, v127
  v_mul_f32 v140, v140, v128
  v_mul_f32 v141, v141, v129
  v_mul_f32 v142, v142, v130
  v_mul_f32 v143, v143, v131
  v_cvt_pk_bf16_f32 v136, v136, v137
  v_cvt_pk_bf16_f32 v137, v138, v139
  v_cvt_pk_bf16_f32 v138, v140, v141
  v_cvt_pk_bf16_f32 v139, v142, v143
  ds_write_b128 v7, v[136:139] offset:57344
  v_mfma_f32_32x32x16_bf16 v[24:39], v[132:135], v[100:103], v[24:39]
  v_lshlrev_b32 v144, 16, v100
  v_and_b32 v145, 0xffff0000, v100
  v_lshlrev_b32 v146, 16, v101
  v_and_b32 v147, 0xffff0000, v101
  v_lshlrev_b32 v148, 16, v102
  v_and_b32 v149, 0xffff0000, v102
  v_lshlrev_b32 v150, 16, v103
  v_and_b32 v151, 0xffff0000, v103
  v_mul_f32 v144, v144, v124
  v_mul_f32 v145, v145, v125
  v_mul_f32 v146, v146, v126
  v_mul_f32 v147, v147, v127
  v_mul_f32 v148, v148, v128
  v_mul_f32 v149, v149, v129
  v_mul_f32 v150, v150, v130
  v_mul_f32 v151, v151, v131
  v_cvt_pk_bf16_f32 v144, v144, v145
  v_cvt_pk_bf16_f32 v145, v146, v147
  v_cvt_pk_bf16_f32 v146, v148, v149
  v_cvt_pk_bf16_f32 v147, v150, v151
  ds_write_b128 v7, v[144:147] offset:58368
  s_waitcnt vmcnt(0) lgkmcnt(2)
  v_mfma_f32_32x32x16_bf16 v[8:23], v[120:123], v[104:107], v[8:23]
  v_lshlrev_b32 v136, 16, v104
  v_and_b32 v137, 0xffff0000, v104
  v_lshlrev_b32 v138, 16, v105
  v_and_b32 v139, 0xffff0000, v105
  v_lshlrev_b32 v140, 16, v106
  v_and_b32 v141, 0xffff0000, v106
  v_lshlrev_b32 v142, 16, v107
  v_and_b32 v143, 0xffff0000, v107
  v_mul_f32 v136, v136, v112
  v_mul_f32 v137, v137, v113
  v_mul_f32 v138, v138, v114
  v_mul_f32 v139, v139, v115
  v_mul_f32 v140, v140, v116
  v_mul_f32 v141, v141, v117
  v_mul_f32 v142, v142, v118
  v_mul_f32 v143, v143, v119
  v_cvt_pk_bf16_f32 v136, v136, v137
  v_cvt_pk_bf16_f32 v137, v138, v139
  v_cvt_pk_bf16_f32 v138, v140, v141
  v_cvt_pk_bf16_f32 v139, v142, v143
  v_add_u32 v7, 65536, v7
  ds_write_b128 v7, v[136:139] offset:0
  v_mfma_f32_32x32x16_bf16 v[24:39], v[120:123], v[108:111], v[24:39]
  v_lshlrev_b32 v144, 16, v108
  v_and_b32 v145, 0xffff0000, v108
  v_lshlrev_b32 v146, 16, v109
  v_and_b32 v147, 0xffff0000, v109
  v_lshlrev_b32 v148, 16, v110
  v_and_b32 v149, 0xffff0000, v110
  v_lshlrev_b32 v150, 16, v111
  v_and_b32 v151, 0xffff0000, v111
  v_mul_f32 v144, v144, v112
  v_mul_f32 v145, v145, v113
  v_mul_f32 v146, v146, v114
  v_mul_f32 v147, v147, v115
  v_mul_f32 v148, v148, v116
  v_mul_f32 v149, v149, v117
  v_mul_f32 v150, v150, v118
  v_mul_f32 v151, v151, v119
  v_cvt_pk_bf16_f32 v144, v144, v145
  v_cvt_pk_bf16_f32 v145, v146, v147
  v_cvt_pk_bf16_f32 v146, v148, v149
  v_cvt_pk_bf16_f32 v147, v150, v151
  ds_write_b128 v7, v[144:147] offset:1024
  v_cmp_lt_u32 vcc, 31, v1
  s_nop 1
  v_cndmask_b32 v152, v8, v24, vcc
  v_cvt_pk_bf16_f32 v153, v152, v152
  v_lshlrev_b32 v153, 16, v153
  v_sub_f32 v153, v152, v153
  v_cvt_pk_bf16_f32 v152, v152, v153
  v_mov_b32 v153, 0x3f80
  v_cmp_eq_u32 vcc, 50, v0
  s_nop 1
  v_cndmask_b32 v152, v152, v153, vcc
  s_lshr_b32 s19, s3, 1
  s_lshl_b32 s19, s19, 8
  s_and_b32 s20, s3, 1
  s_lshl_b32 s20, s20, 2
  s_add_u32 s19, s19, s20
  s_add_u32 s19, s19, 151552
  v_lshl_add_u32 v7, v4, 3, s19
  v_lshl_add_u32 v7, v3, 9, v7
  ds_write_b32 v7, v152
  s_lshl_b32 s19, s3, 10
  v_add_u32 v5, s19, v2
  s_min_u32 s19, s3, 2
  s_lshl_b32 s19, s19, 10
  s_add_u32 s19, s19, 16384
  v_add_u32 v6, s19, v2
  s_mul_i32 s20, s6, 155648
  s_add_u32 s20, s20, 7233536
  s_mul_i32 s21, s7, 19456
  s_add_u32 s21, s21, s20
  s_lshl_b32 s22, s6, 10
  s_add_u32 s22, s22, 24576
  s_lshl_b32 s23, s7, 7
  s_add_u32 s23, s23, s22
  v_and_b32 v7, 7, v0
  v_lshlrev_b32 v7, 7, v7
  s_waitcnt lgkmcnt(0)
  s_barrier
  s_barrier
  ds_read_b128 v[8:11], v5 offset:0
  ds_read_b128 v[12:15], v5 offset:4096
  ds_read_b128 v[16:19], v5 offset:8192
  ds_read_b128 v[20:23], v5 offset:12288
  ds_read_b128 v[24:27], v6
  s_waitcnt lgkmcnt(4)
  s_add_u32 s24, s21, 0
  buffer_store_dwordx4 v[8:11], v5, s[8:11], s24 offen sc1
  s_waitcnt lgkmcnt(3)
  s_add_u32 s24, s21, 4096
  buffer_store_dwordx4 v[12:15], v5, s[8:11], s24 offen sc1
  s_waitcnt lgkmcnt(2)
  s_add_u32 s24, s21, 8192
  buffer_store_dwordx4 v[16:19], v5, s[8:11], s24 offen sc1
  s_waitcnt lgkmcnt(1)
  s_add_u32 s24, s21, 12288
  buffer_store_dwordx4 v[20:23], v5, s[8:11], s24 offen sc1
  s_waitcnt lgkmcnt(0)
  buffer_store_dwordx4 v[24:27], v6, s[8:11], s21 offen sc1
  v_mov_b32 v28, 1
  v_mov_b32 v29, 158720
  v_mov_b32 v31, 0
  s_mov_b64 exec, 1
  s_waitcnt vmcnt(0)
  ds_add_rtn_u32 v30, v29, v28
  s_waitcnt lgkmcnt(0)
  v_readfirstlane_b32 s24, v30
  s_cmp_lg_u32 s24, 3
  s_cbranch_scc1 sk_main_4
  buffer_store_dword v28, v31, s[8:11], s23 offen sc1
sk_main_4:
  s_add_u32 s24, s3, 158724
  v_mov_b32 v150, s24
  s_mov_b32 s26, 0
  s_xor_b32 s24, s7, 1
  s_bitset1_b32 s26, s24
  s_mov_b32 s25, 0
  s_mov_b32 exec_lo, s26
  s_mov_b32 exec_hi, 0
poll_main_5:
  buffer_load_dword v4, v7, s[8:11], s22 offen sc1
  s_waitcnt vmcnt(0)
  v_cmp_eq_u32 vcc, 1, v4
  s_add_u32 s25, s25, 1
  s_and_b32 s24, vcc_lo, s26
  s_cmp_eq_u32 s24, s26
  s_cbranch_scc1 go_main_6
  s_cmp_lt_u32 s25, 262144
  s_cbranch_scc1 poll_main_5
go_main_6:
  s_mov_b64 exec, -1
  s_xor_b32 s24, s7, 1
  s_mul_i32 s24, s24, 19456
  s_add_u32 s24, s24, s20
  buffer_load_dwordx4 v[24:27], v6, s[8:11], s24 offen sc1
  buffer_load_dwordx4 v[8:11], v5, s[8:11], s24 offen sc1
  s_add_u32 s24, s24, 4096
  buffer_load_dwordx4 v[12:15], v5, s[8:11], s24 offen sc1
  s_add_u32 s24, s24, 4096
  buffer_load_dwordx4 v[16:19], v5, s[8:11], s24 offen sc1
  s_add_u32 s24, s24, 4096
  buffer_load_dwordx4 v[20:23], v5, s[8:11], s24 offen sc1
  v_add_u32 v148, 19456, v5
  v_add_u32 v149, 19456, v6
  s_waitcnt vmcnt(0)
  ds_write_b128 v149, v[24:27]
  ds_write_b128 v148, v[8:11] offset:0
  ds_write_b128 v148, v[12:15] offset:4096
  ds_write_b128 v148, v[16:19] offset:8192
  ds_write_b128 v148, v[20:23] offset:12288
  v_mov_b32 v151, 1
  s_waitcnt lgkmcnt(0)
  ds_write_b8 v150, v151
  s_mov_b32 s26, 0
  s_xor_b32 s24, s7, 2
  s_bitset1_b32 s26, s24
  s_xor_b32 s24, s7, 3
  s_bitset1_b32 s26, s24
  s_mov_b32 s25, 0
  s_mov_b32 exec_lo, s26
  s_mov_b32 exec_hi, 0
poll_main_7:
  buffer_load_dword v4, v7, s[8:11], s22 offen sc1
  s_waitcnt vmcnt(0)
  v_cmp_eq_u32 vcc, 1, v4
  s_add_u32 s25, s25, 1
  s_and_b32 s24, vcc_lo, s26
  s_cmp_eq_u32 s24, s26
  s_cbranch_scc1 go_main_8
  s_cmp_lt_u32 s25, 262144
  s_cbranch_scc1 poll_main_7
go_main_8:
  s_mov_b64 exec, -1
  s_xor_b32 s24, s7, 2
  s_mul_i32 s24, s24, 19456
  s_add_u32 s24, s24, s20
  buffer_load_dwordx4 v[44:47], v6, s[8:11], s24 offen sc1
  buffer_load_dwordx4 v[28:31], v5, s[8:11], s24 offen sc1
  s_add_u32 s24, s24, 4096
  buffer_load_dwordx4 v[32:35], v5, s[8:11], s24 offen sc1
  s_add_u32 s24, s24, 4096
  buffer_load_dwordx4 v[36:39], v5, s[8:11], s24 offen sc1
  s_add_u32 s24, s24, 4096
  buffer_load_dwordx4 v[40:43], v5, s[8:11], s24 offen sc1
  s_xor_b32 s24, s7, 3
  s_mul_i32 s24, s24, 19456
  s_add_u32 s24, s24, s20
  buffer_load_dwordx4 v[64:67], v6, s[8:11], s24 offen sc1
  buffer_load_dwordx4 v[48:51], v5, s[8:11], s24 offen sc1
  s_add_u32 s24, s24, 4096
  buffer_load_dwordx4 v[52:55], v5, s[8:11], s24 offen sc1
  s_add_u32 s24, s24, 4096
  buffer_load_dwordx4 v[56:59], v5, s[8:11], s24 offen sc1
  s_add_u32 s24, s24, 4096
  buffer_load_dwordx4 v[60:63], v5, s[8:11], s24 offen sc1
  v_add_u32 v148, 38912, v5
  v_add_u32 v149, 38912, v6
  s_waitcnt vmcnt(5)
  ds_write_b128 v149, v[44:47]
  ds_write_b128 v148, v[28:31] offset:0
  ds_write_b128 v148, v[32:35] offset:4096
  ds_write_b128 v148, v[36:39] offset:8192
  ds_write_b128 v148, v[40:43] offset:12288
  v_mov_b32 v151, 2
  s_waitcnt lgkmcnt(0)
  ds_write_b8 v150, v151
  v_add_u32 v148, 58368, v5
  v_add_u32 v149, 58368, v6
  s_waitcnt vmcnt(0)
  ds_write_b128 v149, v[64:67]
  ds_write_b128 v148, v[48:51] offset:0
  ds_write_b128 v148, v[52:55] offset:4096
  ds_write_b128 v148, v[56:59] offset:8192
  ds_write_b128 v148, v[60:63] offset:12288
  v_mov_b32 v151, 3
  s_waitcnt lgkmcnt(0)
  ds_write_b8 v150, v151
  s_load_dwordx2 s[12:13], s[0:1], 32
  s_load_dwordx2 s[16:17], s[0:1], 40
  s_mov_b32 s14, 5308416
  s_lshl_b32 s28, s3, 8
  s_cmp_lg_u32 s3, 3
  s_cbranch_scc1 tw_main_9
  s_waitcnt lgkmcnt(0)
  s_load_dwordx2 s[12:13], s[0:1], 16
  s_load_dwordx2 s[16:17], s[0:1], 16
  s_mov_b32 s14, 663552
  s_mov_b32 s28, 0
tw_main_9:
  s_mov_b32 s15, 0x20000
  s_mov_b32 s18, s14
  s_mov_b32 s19, 0x20000
  s_add_u32 s28, s28, s2
  s_lshl_b32 s28, s28, 13
  v_lshl_add_u32 v8, v2, 3, s28
  s_mov_b32 s26, 0
  s_xor_b32 s24, s7, 4
  s_bitset1_b32 s26, s24
  s_xor_b32 s24, s7, 5
  s_bitset1_b32 s26, s24
  s_xor_b32 s24, s7, 6
  s_bitset1_b32 s26, s24
  s_xor_b32 s24, s7, 7
  s_bitset1_b32 s26, s24
  s_mov_b32 s25, 0
  s_mov_b32 exec_lo, s26
  s_mov_b32 exec_hi, 0
poll_main_10:
  buffer_load_dword v4, v7, s[8:11], s22 offen sc1
  s_waitcnt vmcnt(0)
  v_cmp_eq_u32 vcc, 1, v4
  s_add_u32 s25, s25, 1
  s_and_b32 s24, vcc_lo, s26
  s_cmp_eq_u32 s24, s26
  s_cbranch_scc1 go_main_11
  s_cmp_lt_u32 s25, 262144
  s_cbranch_scc1 poll_main_10
go_main_11:
  s_mov_b64 exec, -1
  s_xor_b32 s24, s7, 4
  s_mul_i32 s24, s24, 19456
  s_add_u32 s24, s24, s20
  buffer_load_dwordx4 v[84:87], v6, s[8:11], s24 offen sc1
  buffer_load_dwordx4 v[68:71], v5, s[8:11], s24 offen sc1
  s_add_u32 s24, s24, 4096
  buffer_load_dwordx4 v[72:75], v5, s[8:11], s24 offen sc1
  s_add_u32 s24, s24, 4096
  buffer_load_dwordx4 v[76:79], v5, s[8:11], s24 offen sc1
  s_add_u32 s24, s24, 4096
  buffer_load_dwordx4 v[80:83], v5, s[8:11], s24 offen sc1
  s_xor_b32 s24, s7, 5
  s_mul_i32 s24, s24, 19456
  s_add_u32 s24, s24, s20
  buffer_load_dwordx4 v[104:107], v6, s[8:11], s24 offen sc1
  buffer_load_dwordx4 v[88:91], v5, s[8:11], s24 offen sc1
  s_add_u32 s24, s24, 4096
  buffer_load_dwordx4 v[92:95], v5, s[8:11], s24 offen sc1
  s_add_u32 s24, s24, 4096
  buffer_load_dwordx4 v[96:99], v5, s[8:11], s24 offen sc1
  s_add_u32 s24, s24, 4096
  buffer_load_dwordx4 v[100:103], v5, s[8:11], s24 offen sc1
  s_xor_b32 s24, s7, 6
  s_mul_i32 s24, s24, 19456
  s_add_u32 s24, s24, s20
  buffer_load_dwordx4 v[124:127], v6, s[8:11], s24 offen sc1
  buffer_load_dwordx4 v[108:111], v5, s[8:11], s24 offen sc1
  s_add_u32 s24, s24, 4096
  buffer_load_dwordx4 v[112:115], v5, s[8:11], s24 offen sc1
  s_add_u32 s24, s24, 4096
  buffer_load_dwordx4 v[116:119], v5, s[8:11], s24 offen sc1
  s_add_u32 s24, s24, 4096
  buffer_load_dwordx4 v[120:123], v5, s[8:11], s24 offen sc1
  s_xor_b32 s24, s7, 7
  s_mul_i32 s24, s24, 19456
  s_add_u32 s24, s24, s20
  buffer_load_dwordx4 v[144:147], v6, s[8:11], s24 offen sc1
  buffer_load_dwordx4 v[128:131], v5, s[8:11], s24 offen sc1
  s_add_u32 s24, s24, 4096
  buffer_load_dwordx4 v[132:135], v5, s[8:11], s24 offen sc1
  s_add_u32 s24, s24, 4096
  buffer_load_dwordx4 v[136:139], v5, s[8:11], s24 offen sc1
  s_add_u32 s24, s24, 4096
  buffer_load_dwordx4 v[140:143], v5, s[8:11], s24 offen sc1
  s_waitcnt lgkmcnt(0)
  buffer_load_dword v164, v8, s[12:15], 0 offen
  buffer_load_dword v166, v8, s[16:19], 0 offen
  v_add_u32 v148, 77824, v5
  v_add_u32 v149, 77824, v6
  s_waitcnt vmcnt(17)
  ds_write_b128 v149, v[84:87]
  ds_write_b128 v148, v[68:71] offset:0
  ds_write_b128 v148, v[72:75] offset:4096
  ds_write_b128 v148, v[76:79] offset:8192
  ds_write_b128 v148, v[80:83] offset:12288
  v_mov_b32 v151, 4
  s_waitcnt lgkmcnt(0)
  ds_write_b8 v150, v151
  v_add_u32 v148, 97280, v5
  v_add_u32 v149, 97280, v6
  s_waitcnt vmcnt(12)
  ds_write_b128 v149, v[104:107]
  ds_write_b128 v148, v[88:91] offset:0
  ds_write_b128 v148, v[92:95] offset:4096
  ds_write_b128 v148, v[96:99] offset:8192
  ds_write_b128 v148, v[100:103] offset:12288
  v_mov_b32 v151, 5
  s_waitcnt lgkmcnt(0)
  ds_write_b8 v150, v151
  v_add_u32 v148, 116736, v5
  v_add_u32 v149, 116736, v6
  s_waitcnt vmcnt(7)
  ds_write_b128 v149, v[124:127]
  ds_write_b128 v148, v[108:111] offset:0
  ds_write_b128 v148, v[112:115] offset:4096
  ds_write_b128 v148, v[116:119] offset:8192
  ds_write_b128 v148, v[120:123] offset:12288
  v_mov_b32 v151, 6
  s_waitcnt lgkmcnt(0)
  ds_write_b8 v150, v151
  v_add_u32 v148, 136192, v5
  v_add_u32 v149, 136192, v6
  s_waitcnt vmcnt(2)
  ds_write_b128 v149, v[144:147]
  ds_write_b128 v148, v[128:131] offset:0
  ds_write_b128 v148, v[132:135] offset:4096
  ds_write_b128 v148, v[136:139] offset:8192
  ds_write_b128 v148, v[140:143] offset:12288
  v_mov_b32 v151, 127
  s_waitcnt lgkmcnt(0)
  ds_write_b8 v150, v151
  s_mov_b32 s40, 0x05040100
  s_mov_b32 s41, 0x07060302
  v_and_b32 v5, 15, v0
  v_bfe_u32 v3, v0, 4, 2
  s_mov_b32 s15, 0x20000
  s_cmp_lg_u32 s3, 0
  s_cbranch_scc1 w2_main_12
  s_cmp_ge_u32 s2, 216
  s_cbranch_scc1 sent_main_16
  s_load_dwordx2 s[12:13], s[0:1], 32
  s_mov_b32 s14, 5308416
  s_mul_i32 s20, s2, 1821
  s_lshr_b32 s20, s20, 16
  s_mul_i32 s21, s20, 36
  s_sub_u32 s21, s2, s21
  v_mul_u32_u24 v4, 36864, v3
  v_lshl_add_u32 v4, v5, 4, v4
  s_mul_i32 s22, s20, 884736
  s_lshl_b32 s23, s21, 8
  s_add_u32 s22, s22, s23
  v_and_b32 v6, 1, v5
  v_mul_u32_u24 v6, 1152, v6
  v_lshlrev_b32 v7, 3, v3
  v_sub_u32 v6, v7, v6
  v_add_u32 v6, 20992, v6
  s_mul_i32 s23, s20, 192
  s_waitcnt lgkmcnt(0)
  buffer_load_dwordx2 v[104:105], v6, s[8:11], s23 offen offset:0
  buffer_load_dwordx2 v[106:107], v6, s[8:11], s23 offen offset:32
  buffer_load_dwordx2 v[108:109], v6, s[8:11], s23 offen offset:64
  buffer_load_dwordx2 v[110:111], v6, s[8:11], s23 offen offset:96
  buffer_load_dwordx2 v[112:113], v6, s[8:11], s23 offen offset:128
  buffer_load_dwordx2 v[114:115], v6, s[8:11], s23 offen offset:160
  buffer_load_dwordx4 v[8:11], v4, s[12:15], s22 offen
  s_add_u32 s22, s22, 9216
  buffer_load_dwordx4 v[12:15], v4, s[12:15], s22 offen
  s_add_u32 s22, s22, 9216
  buffer_load_dwordx4 v[16:19], v4, s[12:15], s22 offen
  s_add_u32 s22, s22, 9216
  buffer_load_dwordx4 v[20:23], v4, s[12:15], s22 offen
  s_add_u32 s22, s22, 119808
  buffer_load_dwordx4 v[24:27], v4, s[12:15], s22 offen
  s_add_u32 s22, s22, 9216
  buffer_load_dwordx4 v[28:31], v4, s[12:15], s22 offen
  s_add_u32 s22, s22, 9216
  buffer_load_dwordx4 v[32:35], v4, s[12:15], s22 offen
  s_add_u32 s22, s22, 9216
  buffer_load_dwordx4 v[36:39], v4, s[12:15], s22 offen
  s_add_u32 s22, s22, 119808
  buffer_load_dwordx4 v[40:43], v4, s[12:15], s22 offen
  s_add_u32 s22, s22, 9216
  buffer_load_dwordx4 v[44:47], v4, s[12:15], s22 offen
  s_add_u32 s22, s22, 9216
  buffer_load_dwordx4 v[48:51], v4, s[12:15], s22 offen
  s_add_u32 s22, s22, 9216
  buffer_load_dwordx4 v[52:55], v4, s[12:15], s22 offen
  s_add_u32 s22, s22, 119808
  buffer_load_dwordx4 v[56:59], v4, s[12:15], s22 offen
  s_add_u32 s22, s22, 9216
  buffer_load_dwordx4 v[60:63], v4, s[12:15], s22 offen
  s_add_u32 s22, s22, 9216
  buffer_load_dwordx4 v[64:67], v4, s[12:15], s22 offen
  s_add_u32 s22, s22, 9216
  buffer_load_dwordx4 v[68:71], v4, s[12:15], s22 offen
  s_add_u32 s22, s22, 119808
  buffer_load_dwordx4 v[72:75], v4, s[12:15], s22 offen
  s_add_u32 s22, s22, 9216
  buffer_load_dwordx4 v[76:79], v4, s[12:15], s22 offen
  s_add_u32 s22, s22, 9216
  buffer_load_dwordx4 v[80:83], v4, s[12:15], s22 offen
  s_add_u32 s22, s22, 9216
  buffer_load_dwordx4 v[84:87], v4, s[12:15], s22 offen
  s_add_u32 s22, s22, 119808
  buffer_load_dwordx4 v[88:91], v4, s[12:15], s22 offen
  s_add_u32 s22, s22, 9216
  buffer_load_dwordx4 v[92:95], v4, s[12:15], s22 offen
  s_add_u32 s22, s22, 9216
  buffer_load_dwordx4 v[96:99], v4, s[12:15], s22 offen
  s_add_u32 s22, s22, 9216
  buffer_load_dwordx4 v[100:103], v4, s[12:15], s22 offen
  s_lshl_b32 s21, s21, 3
  s_mul_i32 s22, s20, 9216
  s_add_u32 s22, s22, 15237120
  s_add_u32 s23, s21, 0
  s_mul_i32 s24, s23, 21846
  s_lshr_b32 s24, s24, 16
  s_mul_i32 s24, s24, 55296
  s_lshl_b32 s23, s23, 10
  s_add_u32 s23, s23, s22
  s_add_u32 s28, s23, s24
  s_add_u32 s23, s21, 1
  s_mul_i32 s24, s23, 21846
  s_lshr_b32 s24, s24, 16
  s_mul_i32 s24, s24, 55296
  s_lshl_b32 s23, s23, 10
  s_add_u32 s23, s23, s22
  s_add_u32 s29, s23, s24
  s_add_u32 s23, s21, 2
  s_mul_i32 s24, s23, 21846
  s_lshr_b32 s24, s24, 16
  s_mul_i32 s24, s24, 55296
  s_lshl_b32 s23, s23, 10
  s_add_u32 s23, s23, s22
  s_add_u32 s30, s23, s24
  s_add_u32 s23, s21, 3
  s_mul_i32 s24, s23, 21846
  s_lshr_b32 s24, s24, 16
  s_mul_i32 s24, s24, 55296
  s_lshl_b32 s23, s23, 10
  s_add_u32 s23, s23, s22
  s_add_u32 s31, s23, s24
  s_add_u32 s23, s21, 4
  s_mul_i32 s24, s23, 21846
  s_lshr_b32 s24, s24, 16
  s_mul_i32 s24, s24, 55296
  s_lshl_b32 s23, s23, 10
  s_add_u32 s23, s23, s22
  s_add_u32 s32, s23, s24
  s_add_u32 s23, s21, 5
  s_mul_i32 s24, s23, 21846
  s_lshr_b32 s24, s24, 16
  s_mul_i32 s24, s24, 55296
  s_lshl_b32 s23, s23, 10
  s_add_u32 s23, s23, s22
  s_add_u32 s33, s23, s24
  s_add_u32 s23, s21, 6
  s_mul_i32 s24, s23, 21846
  s_lshr_b32 s24, s24, 16
  s_mul_i32 s24, s24, 55296
  s_lshl_b32 s23, s23, 10
  s_add_u32 s23, s23, s22
  s_add_u32 s34, s23, s24
  s_add_u32 s23, s21, 7
  s_mul_i32 s24, s23, 21846
  s_lshr_b32 s24, s24, 16
  s_mul_i32 s24, s24, 55296
  s_lshl_b32 s23, s23, 10
  s_add_u32 s23, s23, s22
  s_add_u32 s35, s23, s24
  v_add_u32 v6, 6144, v2
  s_mul_i32 s23, s20, 9088
  s_sub_u32 s23, 55296, s23
  v_lshl_add_u32 v7, v5, 3, s23
  s_waitcnt vmcnt(16)
  v_perm_b32 v148, v12, v8, s40
  v_perm_b32 v149, v20, v16, s40
  v_perm_b32 v150, v28, v24, s40
  v_perm_b32 v151, v36, v32, s40
  buffer_store_dwordx4 v[148:151], v2, s[8:11], s28 offen offset:0 sc1
  s_nop 0
  v_mfma_f32_16x16x32_bf16 v[116:119], v[104:107], v[148:151], 0
  v_perm_b32 v152, v12, v8, s41
  v_perm_b32 v153, v20, v16, s41
  v_perm_b32 v154, v28, v24, s41
  v_perm_b32 v155, v36, v32, s41
  buffer_store_dwordx4 v[152:155], v2, s[8:11], s29 offen offset:0 sc1
  s_nop 0
  v_mfma_f32_16x16x32_bf16 v[120:123], v[104:107], v[152:155], 0
  v_perm_b32 v156, v13, v9, s40
  v_perm_b32 v157, v21, v17, s40
  v_perm_b32 v158, v29, v25, s40
  v_perm_b32 v159, v37, v33, s40
  buffer_store_dwordx4 v[156:159], v2, s[8:11], s30 offen offset:0 sc1
  s_nop 0
  v_mfma_f32_16x16x32_bf16 v[124:127], v[104:107], v[156:159], 0
  v_perm_b32 v160, v13, v9, s41
  v_perm_b32 v161, v21, v17, s41
  v_perm_b32 v162, v29, v25, s41
  v_perm_b32 v163, v37, v33, s41
  buffer_store_dwordx4 v[160:163], v2, s[8:11], s31 offen offset:0 sc1
  s_nop 0
  v_mfma_f32_16x16x32_bf16 v[128:131], v[104:107], v[160:163], 0
  v_perm_b32 v148, v14, v10, s40
  v_perm_b32 v149, v22, v18, s40
  v_perm_b32 v150, v30, v26, s40
  v_perm_b32 v151, v38, v34, s40
  buffer_store_dwordx4 v[148:151], v2, s[8:11], s32 offen offset:0 sc1
  s_nop 0
  v_mfma_f32_16x16x32_bf16 v[132:135], v[104:107], v[148:151], 0
  v_perm_b32 v152, v14, v10, s41
  v_perm_b32 v153, v22, v18, s41
  v_perm_b32 v154, v30, v26, s41
  v_perm_b32 v155, v38, v34, s41
  buffer_store_dwordx4 v[152:155], v2, s[8:11], s33 offen offset:0 sc1
  s_nop 0
  v_mfma_f32_16x16x32_bf16 v[136:139], v[104:107], v[152:155], 0
  v_perm_b32 v156, v15, v11, s40
  v_perm_b32 v157, v23, v19, s40
  v_perm_b32 v158, v31, v27, s40
  v_perm_b32 v159, v39, v35, s40
  buffer_store_dwordx4 v[156:159], v2, s[8:11], s34 offen offset:0 sc1
  s_nop 0
  v_mfma_f32_16x16x32_bf16 v[140:143], v[104:107], v[156:159], 0
  v_perm_b32 v160, v15, v11, s41
  v_perm_b32 v161, v23, v19, s41
  v_perm_b32 v162, v31, v27, s41
  v_perm_b32 v163, v39, v35, s41
  buffer_store_dwordx4 v[160:163], v2, s[8:11], s35 offen offset:0 sc1
  s_nop 0
  v_mfma_f32_16x16x32_bf16 v[144:147], v[104:107], v[160:163], 0
  s_waitcnt vmcnt(16)
  v_perm_b32 v148, v44, v40, s40
  v_perm_b32 v149, v52, v48, s40
  v_perm_b32 v150, v60, v56, s40
  v_perm_b32 v151, v68, v64, s40
  buffer_store_dwordx4 v[148:151], v2, s[8:11], s28 offen offset:3072 sc1
  s_nop 0
  v_mfma_f32_16x16x32_bf16 v[116:119], v[108:111], v[148:151], v[116:119]
  v_perm_b32 v152, v44, v40, s41
  v_perm_b32 v153, v52, v48, s41
  v_perm_b32 v154, v60, v56, s41
  v_perm_b32 v155, v68, v64, s41
  buffer_store_dwordx4 v[152:155], v2, s[8:11], s29 offen offset:3072 sc1
  s_nop 0
  v_mfma_f32_16x16x32_bf16 v[120:123], v[108:111], v[152:155], v[120:123]
  v_perm_b32 v156, v45, v41, s40
  v_perm_b32 v157, v53, v49, s40
  v_perm_b32 v158, v61, v57, s40
  v_perm_b32 v159, v69, v65, s40
  buffer_store_dwordx4 v[156:159], v2, s[8:11], s30 offen offset:3072 sc1
  s_nop 0
  v_mfma_f32_16x16x32_bf16 v[124:127], v[108:111], v[156:159], v[124:127]
  v_perm_b32 v160, v45, v41, s41
  v_perm_b32 v161, v53, v49, s41
  v_perm_b32 v162, v61, v57, s41
  v_perm_b32 v163, v69, v65, s41
  buffer_store_dwordx4 v[160:163], v2, s[8:11], s31 offen offset:3072 sc1
  s_nop 0
  v_mfma_f32_16x16x32_bf16 v[128:131], v[108:111], v[160:163], v[128:131]
  v_perm_b32 v148, v46, v42, s40
  v_perm_b32 v149, v54, v50, s40
  v_perm_b32 v150, v62, v58, s40
  v_perm_b32 v151, v70, v66, s40
  buffer_store_dwordx4 v[148:151], v2, s[8:11], s32 offen offset:3072 sc1
  s_nop 0
  v_mfma_f32_16x16x32_bf16 v[132:135], v[108:111], v[148:151], v[132:135]
  v_perm_b32 v152, v46, v42, s41
  v_perm_b32 v153, v54, v50, s41
  v_perm_b32 v154, v62, v58, s41
  v_perm_b32 v155, v70, v66, s41
  buffer_store_dwordx4 v[152:155], v2, s[8:11], s33 offen offset:3072 sc1
  s_nop 0
  v_mfma_f32_16x16x32_bf16 v[136:139], v[108:111], v[152:155], v[136:139]
  v_perm_b32 v156, v47, v43, s40
  v_perm_b32 v157, v55, v51, s40
  v_perm_b32 v158, v63, v59, s40
  v_perm_b32 v159, v71, v67, s40
  buffer_store_dwordx4 v[156:159], v2, s[8:11], s34 offen offset:3072 sc1
  s_nop 0
  v_mfma_f32_16x16x32_bf16 v[140:143], v[108:111], v[156:159], v[140:143]
  v_perm_b32 v160, v47, v43, s41
  v_perm_b32 v161, v55, v51, s41
  v_perm_b32 v162, v63, v59, s41
  v_perm_b32 v163, v71, v67, s41
  buffer_store_dwordx4 v[160:163], v2, s[8:11], s35 offen offset:3072 sc1
  s_nop 0
  v_mfma_f32_16x16x32_bf16 v[144:147], v[108:111], v[160:163], v[144:147]
  s_waitcnt vmcnt(16)
  v_perm_b32 v148, v76, v72, s40
  v_perm_b32 v149, v84, v80, s40
  v_perm_b32 v150, v92, v88, s40
  v_perm_b32 v151, v100, v96, s40
  buffer_store_dwordx4 v[148:151], v6, s[8:11], s28 offen offset:0 sc1
  s_nop 0
  v_mfma_f32_16x16x32_bf16 v[116:119], v[112:115], v[148:151], v[116:119]
  v_perm_b32 v152, v76, v72, s41
  v_perm_b32 v153, v84, v80, s41
  v_perm_b32 v154, v92, v88, s41
  v_perm_b32 v155, v100, v96, s41
  buffer_store_dwordx4 v[152:155], v6, s[8:11], s29 offen offset:0 sc1
  s_nop 0
  v_mfma_f32_16x16x32_bf16 v[120:123], v[112:115], v[152:155], v[120:123]
  v_perm_b32 v156, v77, v73, s40
  v_perm_b32 v157, v85, v81, s40
  v_perm_b32 v158, v93, v89, s40
  v_perm_b32 v159, v101, v97, s40
  buffer_store_dwordx4 v[156:159], v6, s[8:11], s30 offen offset:0 sc1
  s_nop 0
  v_mfma_f32_16x16x32_bf16 v[124:127], v[112:115], v[156:159], v[124:127]
  v_perm_b32 v160, v77, v73, s41
  v_perm_b32 v161, v85, v81, s41
  v_perm_b32 v162, v93, v89, s41
  v_perm_b32 v163, v101, v97, s41
  buffer_store_dwordx4 v[160:163], v6, s[8:11], s31 offen offset:0 sc1
  s_nop 0
  v_mfma_f32_16x16x32_bf16 v[128:131], v[112:115], v[160:163], v[128:131]
  v_perm_b32 v148, v78, v74, s40
  v_perm_b32 v149, v86, v82, s40
  v_perm_b32 v150, v94, v90, s40
  v_perm_b32 v151, v102, v98, s40
  buffer_store_dwordx4 v[148:151], v6, s[8:11], s32 offen offset:0 sc1
  s_nop 0
  v_mfma_f32_16x16x32_bf16 v[132:135], v[112:115], v[148:151], v[132:135]
  v_perm_b32 v152, v78, v74, s41
  v_perm_b32 v153, v86, v82, s41
  v_perm_b32 v154, v94, v90, s41
  v_perm_b32 v155, v102, v98, s41
  buffer_store_dwordx4 v[152:155], v6, s[8:11], s33 offen offset:0 sc1
  s_nop 0
  v_mfma_f32_16x16x32_bf16 v[136:139], v[112:115], v[152:155], v[136:139]
  v_perm_b32 v156, v79, v75, s40
  v_perm_b32 v157, v87, v83, s40
  v_perm_b32 v158, v95, v91, s40
  v_perm_b32 v159, v103, v99, s40
  buffer_store_dwordx4 v[156:159], v6, s[8:11], s34 offen offset:0 sc1
  s_nop 0
  v_mfma_f32_16x16x32_bf16 v[140:143], v[112:115], v[156:159], v[140:143]
  v_perm_b32 v160, v79, v75, s41
  v_perm_b32 v161, v87, v83, s41
  v_perm_b32 v162, v95, v91, s41
  v_perm_b32 v163, v103, v99, s41
  buffer_store_dwordx4 v[160:163], v6, s[8:11], s35 offen offset:0 sc1
  s_nop 0
  v_mfma_f32_16x16x32_bf16 v[144:147], v[112:115], v[160:163], v[144:147]
  s_waitcnt vmcnt(0)
  s_mov_b64 exec, 0xffff
  v_cvt_pk_bf16_f32 v8, v116, v117
  v_lshlrev_b32 v118, 16, v8
  v_and_b32 v119, 0xffff0000, v8
  v_sub_f32 v116, v116, v118
  v_sub_f32 v117, v117, v119
  v_cvt_pk_bf16_f32 v9, v116, v117
  buffer_store_dwordx2 v[8:9], v7, s[8:11], s28 offen sc1
  v_cvt_pk_bf16_f32 v10, v120, v121
  v_lshlrev_b32 v122, 16, v10
  v_and_b32 v123, 0xffff0000, v10
  v_sub_f32 v120, v120, v122
  v_sub_f32 v121, v121, v123
  v_cvt_pk_bf16_f32 v11, v120, v121
  buffer_store_dwordx2 v[10:11], v7, s[8:11], s29 offen sc1
  v_cvt_pk_bf16_f32 v12, v124, v125
  v_lshlrev_b32 v126, 16, v12
  v_and_b32 v127, 0xffff0000, v12
  v_sub_f32 v124, v124, v126
  v_sub_f32 v125, v125, v127
  v_cvt_pk_bf16_f32 v13, v124, v125
  buffer_store_dwordx2 v[12:13], v7, s[8:11], s30 offen sc1
  v_cvt_pk_bf16_f32 v14, v128, v129
  v_lshlrev_b32 v130, 16, v14
  v_and_b32 v131, 0xffff0000, v14
  v_sub_f32 v128, v128, v130
  v_sub_f32 v129, v129, v131
  v_cvt_pk_bf16_f32 v15, v128, v129
  buffer_store_dwordx2 v[14:15], v7, s[8:11], s31 offen sc1
  v_cvt_pk_bf16_f32 v16, v132, v133
  v_lshlrev_b32 v134, 16, v16
  v_and_b32 v135, 0xffff0000, v16
  v_sub_f32 v132, v132, v134
  v_sub_f32 v133, v133, v135
  v_cvt_pk_bf16_f32 v17, v132, v133
  buffer_store_dwordx2 v[16:17], v7, s[8:11], s32 offen sc1
  v_cvt_pk_bf16_f32 v18, v136, v137
  v_lshlrev_b32 v138, 16, v18
  v_and_b32 v139, 0xffff0000, v18
  v_sub_f32 v136, v136, v138
  v_sub_f32 v137, v137, v139
  v_cvt_pk_bf16_f32 v19, v136, v137
  buffer_store_dwordx2 v[18:19], v7, s[8:11], s33 offen sc1
  v_cvt_pk_bf16_f32 v20, v140, v141
  v_lshlrev_b32 v142, 16, v20
  v_and_b32 v143, 0xffff0000, v20
  v_sub_f32 v140, v140, v142
  v_sub_f32 v141, v141, v143
  v_cvt_pk_bf16_f32 v21, v140, v141
  buffer_store_dwordx2 v[20:21], v7, s[8:11], s34 offen sc1
  v_cvt_pk_bf16_f32 v22, v144, v145
  v_lshlrev_b32 v146, 16, v22
  v_and_b32 v147, 0xffff0000, v22
  v_sub_f32 v144, v144, v146
  v_sub_f32 v145, v145, v147
  v_cvt_pk_bf16_f32 v23, v144, v145
  buffer_store_dwordx2 v[22:23], v7, s[8:11], s35 offen sc1
  s_mov_b64 exec, -1
  s_branch sent_main_16
w2_main_12:
  s_mul_i32 s20, s2, 3
  s_add_u32 s20, s20, s3
  s_sub_u32 s20, s20, 1
  s_cmp_ge_u32 s20, 648
  s_cbranch_scc1 sent_main_16
  s_cmp_ge_u32 s20, 648
  s_cselect_b32 s21, 648, 0
  s_sub_u32 s21, s20, s21
  s_lshl_b32 s22, s21, 4
  v_add_u32 v7, s22, v5
  v_mul_u32_u24 v8, 58255, v7
  v_lshrrev_b32 v8, 22, v8
  v_mul_u32_u24 v9, 72, v8
  v_sub_u32 v9, v7, v9
  s_mov_b32 s24, 0
  s_mov_b32 s25, 1152
  s_mov_b32 s26, 2304
  s_mov_b32 s27, 3456
  s_cmp_ge_u32 s20, 648
  s_cbranch_scc1 wo_main_13
  s_load_dwordx2 s[12:13], s[0:1], 40
  s_mov_b32 s14, 5308416
  s_mov_b32 s22, 20840448
  v_and_b32 v10, 0xfc, v8
  v_add_u32 v10, v10, v3
  v_and_b32 v4, 3, v8
  v_lshl_add_u32 v10, v10, 4, v4
  v_mul_u32_u24 v4, 2304, v10
  v_lshl_add_u32 v4, v9, 4, v4
  v_add_u32 v1, 1152, v4
  s_mov_b32 s25, 9216
  s_mov_b32 s26, 18432
  s_mov_b32 s27, 27648
  s_branch q_main_15
wo_main_13:
  s_load_dwordx2 s[12:13], s[0:1], 16
  s_mov_b32 s14, 663552
  s_mov_b32 s22, 14573568
  s_cmp_ge_u32 s21, 72
  s_cbranch_scc1 wx_main_14
  v_lshrrev_b32 v10, 1, v3
  v_lshl_add_u32 v10, v8, 1, v10
  v_mul_u32_u24 v10, 18, v10
  v_and_b32 v12, 1, v3
  v_lshl_add_u32 v10, v12, 2, v10
  v_mul_u32_u24 v4, 1152, v10
  v_lshl_add_u32 v4, v9, 4, v4
  v_add_u32 v1, 9216, v4
  s_branch q_main_15
wx_main_14:
  v_subrev_u32 v10, 16, v8
  v_lshlrev_b32 v10, 2, v10
  v_add_u32 v10, v10, v3
  v_mul_u32_u24 v10, 72, v10
  v_add_u32 v10, 16, v10
  v_mul_u32_u24 v4, 1152, v10
  v_lshl_add_u32 v4, v9, 4, v4
  v_add_u32 v1, 41472, v4
  s_mov_b32 s26, 20736
  s_mov_b32 s27, 21888
q_main_15:
  s_waitcnt lgkmcnt(0)
  buffer_load_dwordx4 v[12:15], v4, s[12:15], s24 offen
  buffer_load_dwordx4 v[16:19], v4, s[12:15], s25 offen
  buffer_load_dwordx4 v[20:23], v4, s[12:15], s26 offen
  buffer_load_dwordx4 v[24:27], v4, s[12:15], s27 offen
  buffer_load_dwordx4 v[28:31], v1, s[12:15], s24 offen
  buffer_load_dwordx4 v[32:35], v1, s[12:15], s25 offen
  buffer_load_dwordx4 v[36:39], v1, s[12:15], s26 offen
  buffer_load_dwordx4 v[40:43], v1, s[12:15], s27 offen
  v_mul_u32_u24 v10, 3641, v8
  v_lshrrev_b32 v10, 16, v10
  v_mul_u32_u24 v10, 608256, v10
  v_mul_u32_u24 v11, 3072, v8
  v_add_u32 v10, v10, v11
  v_mul_u32_u24 v11, 10923, v9
  v_lshrrev_b32 v11, 16, v11
  v_mul_u32_u24 v11, 52224, v11
  v_add_u32 v10, v10, v11
  v_lshrrev_b32 v11, 1, v9
  v_lshl_add_u32 v10, v11, 10, v10
  v_and_b32 v11, 1, v9
  v_lshl_add_u32 v10, v11, 7, v10
  v_lshl_add_u32 v6, v3, 8, v10
  v_and_b32 v44, 56, v0
  v_lshlrev_b32 v44, 2, v44
  ds_bpermute_b32 v68, v44, v6 offset:0
  ds_bpermute_b32 v69, v44, v6 offset:4
  ds_bpermute_b32 v70, v44, v6 offset:8
  ds_bpermute_b32 v71, v44, v6 offset:12
  ds_bpermute_b32 v72, v44, v6 offset:16
  ds_bpermute_b32 v73, v44, v6 offset:20
  ds_bpermute_b32 v74, v44, v6 offset:24
  ds_bpermute_b32 v75, v44, v6 offset:28
  v_and_b32 v44, 0x70, v2
  s_waitcnt lgkmcnt(0)
  v_add_u32 v68, v68, v44
  v_add_u32 v69, v69, v44
  v_add_u32 v70, v70, v44
  v_add_u32 v71, v71, v44
  v_add_u32 v72, v72, v44
  v_add_u32 v73, v73, v44
  v_add_u32 v74, v74, v44
  v_add_u32 v75, v75, v44
  s_waitcnt vmcnt(0)
  v_perm_b32 v44, v16, v12, s40
  v_perm_b32 v45, v24, v20, s40
  v_perm_b32 v46, v32, v28, s40
  v_perm_b32 v47, v40, v36, s40
  v_perm_b32 v48, v16, v12, s41
  v_perm_b32 v49, v24, v20, s41
  v_perm_b32 v50, v32, v28, s41
  v_perm_b32 v51, v40, v36, s41
  v_perm_b32 v52, v17, v13, s40
  v_perm_b32 v53, v25, v21, s40
  v_perm_b32 v54, v33, v29, s40
  v_perm_b32 v55, v41, v37, s40
  v_perm_b32 v56, v17, v13, s41
  v_perm_b32 v57, v25, v21, s41
  v_perm_b32 v58, v33, v29, s41
  v_perm_b32 v59, v41, v37, s41
  s_mov_b32 vcc_lo, 0x55555555
  s_mov_b32 vcc_hi, vcc_lo
  v_cndmask_b32_dpp v12, v48, v44, vcc quad_perm:[1,0,3,2] row_mask:0xf bank_mask:0xf
  v_cndmask_b32_dpp v13, v49, v45, vcc quad_perm:[1,0,3,2] row_mask:0xf bank_mask:0xf
  v_cndmask_b32_dpp v16, v50, v46, vcc quad_perm:[1,0,3,2] row_mask:0xf bank_mask:0xf
  v_cndmask_b32_dpp v17, v51, v47, vcc quad_perm:[1,0,3,2] row_mask:0xf bank_mask:0xf
  v_cndmask_b32_dpp v28, v56, v52, vcc quad_perm:[1,0,3,2] row_mask:0xf bank_mask:0xf
  v_cndmask_b32_dpp v29, v57, v53, vcc quad_perm:[1,0,3,2] row_mask:0xf bank_mask:0xf
  v_cndmask_b32_dpp v32, v58, v54, vcc quad_perm:[1,0,3,2] row_mask:0xf bank_mask:0xf
  v_cndmask_b32_dpp v33, v59, v55, vcc quad_perm:[1,0,3,2] row_mask:0xf bank_mask:0xf
  s_not_b64 vcc, vcc
  v_cndmask_b32_dpp v20, v44, v48, vcc quad_perm:[1,0,3,2] row_mask:0xf bank_mask:0xf
  v_cndmask_b32_dpp v21, v45, v49, vcc quad_perm:[1,0,3,2] row_mask:0xf bank_mask:0xf
  v_cndmask_b32_dpp v24, v46, v50, vcc quad_perm:[1,0,3,2] row_mask:0xf bank_mask:0xf
  v_cndmask_b32_dpp v25, v47, v51, vcc quad_perm:[1,0,3,2] row_mask:0xf bank_mask:0xf
  v_cndmask_b32_dpp v36, v52, v56, vcc quad_perm:[1,0,3,2] row_mask:0xf bank_mask:0xf
  v_cndmask_b32_dpp v37, v53, v57, vcc quad_perm:[1,0,3,2] row_mask:0xf bank_mask:0xf
  v_cndmask_b32_dpp v40, v54, v58, vcc quad_perm:[1,0,3,2] row_mask:0xf bank_mask:0xf
  v_cndmask_b32_dpp v41, v55, v59, vcc quad_perm:[1,0,3,2] row_mask:0xf bank_mask:0xf
  v_perm_b32 v44, v18, v14, s40
  v_perm_b32 v45, v26, v22, s40
  v_perm_b32 v46, v34, v30, s40
  v_perm_b32 v47, v42, v38, s40
  v_perm_b32 v48, v18, v14, s41
  v_perm_b32 v49, v26, v22, s41
  v_perm_b32 v50, v34, v30, s41
  v_perm_b32 v51, v42, v38, s41
  v_perm_b32 v52, v19, v15, s40
  v_perm_b32 v53, v27, v23, s40
  v_perm_b32 v54, v35, v31, s40
  v_perm_b32 v55, v43, v39, s40
  v_perm_b32 v56, v19, v15, s41
  v_perm_b32 v57, v27, v23, s41
  v_perm_b32 v58, v35, v31, s41
  v_perm_b32 v59, v43, v39, s41
  s_mov_b32 vcc_lo, 0x55555555
  s_mov_b32 vcc_hi, vcc_lo
  v_cndmask_b32_dpp v14, v48, v44, vcc quad_perm:[1,0,3,2] row_mask:0xf bank_mask:0xf
  v_cndmask_b32_dpp v15, v49, v45, vcc quad_perm:[1,0,3,2] row_mask:0xf bank_mask:0xf
  v_cndmask_b32_dpp v18, v50, v46, vcc quad_perm:[1,0,3,2] row_mask:0xf bank_mask:0xf
  v_cndmask_b32_dpp v19, v51, v47, vcc quad_perm:[1,0,3,2] row_mask:0xf bank_mask:0xf
  v_cndmask_b32_dpp v30, v56, v52, vcc quad_perm:[1,0,3,2] row_mask:0xf bank_mask:0xf
  v_cndmask_b32_dpp v31, v57, v53, vcc quad_perm:[1,0,3,2] row_mask:0xf bank_mask:0xf
  v_cndmask_b32_dpp v34, v58, v54, vcc quad_perm:[1,0,3,2] row_mask:0xf bank_mask:0xf
  v_cndmask_b32_dpp v35, v59, v55, vcc quad_perm:[1,0,3,2] row_mask:0xf bank_mask:0xf
  s_not_b64 vcc, vcc
  v_cndmask_b32_dpp v22, v44, v48, vcc quad_perm:[1,0,3,2] row_mask:0xf bank_mask:0xf
  v_cndmask_b32_dpp v23, v45, v49, vcc quad_perm:[1,0,3,2] row_mask:0xf bank_mask:0xf
  v_cndmask_b32_dpp v26, v46, v50, vcc quad_perm:[1,0,3,2] row_mask:0xf bank_mask:0xf
  v_cndmask_b32_dpp v27, v47, v51, vcc quad_perm:[1,0,3,2] row_mask:0xf bank_mask:0xf
  v_cndmask_b32_dpp v38, v52, v56, vcc quad_perm:[1,0,3,2] row_mask:0xf bank_mask:0xf
  v_cndmask_b32_dpp v39, v53, v57, vcc quad_perm:[1,0,3,2] row_mask:0xf bank_mask:0xf
  v_cndmask_b32_dpp v42, v54, v58, vcc quad_perm:[1,0,3,2] row_mask:0xf bank_mask:0xf
  v_cndmask_b32_dpp v43, v55, v59, vcc quad_perm:[1,0,3,2] row_mask:0xf bank_mask:0xf
  s_mov_b32 vcc_lo, 0x33333333
  s_mov_b32 vcc_hi, vcc_lo
  v_cndmask_b32_dpp v44, v28, v12, vcc quad_perm:[2,3,0,1] row_mask:0xf bank_mask:0xf
  v_cndmask_b32_dpp v45, v29, v13, vcc quad_perm:[2,3,0,1] row_mask:0xf bank_mask:0xf
  v_cndmask_b32_dpp v46, v32, v16, vcc quad_perm:[2,3,0,1] row_mask:0xf bank_mask:0xf
  v_cndmask_b32_dpp v47, v33, v17, vcc quad_perm:[2,3,0,1] row_mask:0xf bank_mask:0xf
  v_cndmask_b32_dpp v48, v36, v20, vcc quad_perm:[2,3,0,1] row_mask:0xf bank_mask:0xf
  v_cndmask_b32_dpp v49, v37, v21, vcc quad_perm:[2,3,0,1] row_mask:0xf bank_mask:0xf
  v_cndmask_b32_dpp v50, v40, v24, vcc quad_perm:[2,3,0,1] row_mask:0xf bank_mask:0xf
  v_cndmask_b32_dpp v51, v41, v25, vcc quad_perm:[2,3,0,1] row_mask:0xf bank_mask:0xf
  v_cndmask_b32_dpp v52, v30, v14, vcc quad_perm:[2,3,0,1] row_mask:0xf bank_mask:0xf
  v_cndmask_b32_dpp v53, v31, v15, vcc quad_perm:[2,3,0,1] row_mask:0xf bank_mask:0xf
  v_cndmask_b32_dpp v54, v34, v18, vcc quad_perm:[2,3,0,1] row_mask:0xf bank_mask:0xf
  v_cndmask_b32_dpp v55, v35, v19, vcc quad_perm:[2,3,0,1] row_mask:0xf bank_mask:0xf
  v_cndmask_b32_dpp v56, v38, v22, vcc quad_perm:[2,3,0,1] row_mask:0xf bank_mask:0xf
  v_cndmask_b32_dpp v57, v39, v23, vcc quad_perm:[2,3,0,1] row_mask:0xf bank_mask:0xf
  v_cndmask_b32_dpp v58, v42, v26, vcc quad_perm:[2,3,0,1] row_mask:0xf bank_mask:0xf
  v_cndmask_b32_dpp v59, v43, v27, vcc quad_perm:[2,3,0,1] row_mask:0xf bank_mask:0xf
  s_not_b64 vcc, vcc
  v_cndmask_b32_dpp v28, v12, v28, vcc quad_perm:[2,3,0,1] row_mask:0xf bank_mask:0xf
  v_cndmask_b32_dpp v29, v13, v29, vcc quad_perm:[2,3,0,1] row_mask:0xf bank_mask:0xf
  v_cndmask_b32_dpp v32, v16, v32, vcc quad_perm:[2,3,0,1] row_mask:0xf bank_mask:0xf
  v_cndmask_b32_dpp v33, v17, v33, vcc quad_perm:[2,3,0,1] row_mask:0xf bank_mask:0xf
  v_cndmask_b32_dpp v36, v20, v36, vcc quad_perm:[2,3,0,1] row_mask:0xf bank_mask:0xf
  v_cndmask_b32_dpp v37, v21, v37, vcc quad_perm:[2,3,0,1] row_mask:0xf bank_mask:0xf
  v_cndmask_b32_dpp v40, v24, v40, vcc quad_perm:[2,3,0,1] row_mask:0xf bank_mask:0xf
  v_cndmask_b32_dpp v41, v25, v41, vcc quad_perm:[2,3,0,1] row_mask:0xf bank_mask:0xf
  v_cndmask_b32_dpp v30, v14, v30, vcc quad_perm:[2,3,0,1] row_mask:0xf bank_mask:0xf
  v_cndmask_b32_dpp v31, v15, v31, vcc quad_perm:[2,3,0,1] row_mask:0xf bank_mask:0xf
  v_cndmask_b32_dpp v34, v18, v34, vcc quad_perm:[2,3,0,1] row_mask:0xf bank_mask:0xf
  v_cndmask_b32_dpp v35, v19, v35, vcc quad_perm:[2,3,0,1] row_mask:0xf bank_mask:0xf
  v_cndmask_b32_dpp v38, v22, v38, vcc quad_perm:[2,3,0,1] row_mask:0xf bank_mask:0xf
  v_cndmask_b32_dpp v39, v23, v39, vcc quad_perm:[2,3,0,1] row_mask:0xf bank_mask:0xf
  v_cndmask_b32_dpp v42, v26, v42, vcc quad_perm:[2,3,0,1] row_mask:0xf bank_mask:0xf
  v_cndmask_b32_dpp v43, v27, v43, vcc quad_perm:[2,3,0,1] row_mask:0xf bank_mask:0xf
  s_mov_b32 vcc_lo, 0xf0f0f0f
  s_mov_b32 vcc_hi, vcc_lo
  v_cndmask_b32_dpp v12, v30, v28, vcc row_ror:4 row_mask:0xf bank_mask:0xf
  v_cndmask_b32_dpp v13, v31, v29, vcc row_ror:4 row_mask:0xf bank_mask:0xf
  v_cndmask_b32_dpp v14, v34, v32, vcc row_ror:4 row_mask:0xf bank_mask:0xf
  v_cndmask_b32_dpp v15, v35, v33, vcc row_ror:4 row_mask:0xf bank_mask:0xf
  v_cndmask_b32_dpp v20, v38, v36, vcc row_ror:4 row_mask:0xf bank_mask:0xf
  v_cndmask_b32_dpp v21, v39, v37, vcc row_ror:4 row_mask:0xf bank_mask:0xf
  v_cndmask_b32_dpp v22, v42, v40, vcc row_ror:4 row_mask:0xf bank_mask:0xf
  v_cndmask_b32_dpp v23, v43, v41, vcc row_ror:4 row_mask:0xf bank_mask:0xf
  s_not_b64 vcc, vcc
  v_cndmask_b32_dpp v16, v28, v30, vcc row_ror:12 row_mask:0xf bank_mask:0xf
  v_cndmask_b32_dpp v17, v29, v31, vcc row_ror:12 row_mask:0xf bank_mask:0xf
  v_cndmask_b32_dpp v18, v32, v34, vcc row_ror:12 row_mask:0xf bank_mask:0xf
  v_cndmask_b32_dpp v19, v33, v35, vcc row_ror:12 row_mask:0xf bank_mask:0xf
  v_cndmask_b32_dpp v24, v36, v38, vcc row_ror:12 row_mask:0xf bank_mask:0xf
  v_cndmask_b32_dpp v25, v37, v39, vcc row_ror:12 row_mask:0xf bank_mask:0xf
  v_cndmask_b32_dpp v26, v40, v42, vcc row_ror:12 row_mask:0xf bank_mask:0xf
  v_cndmask_b32_dpp v27, v41, v43, vcc row_ror:12 row_mask:0xf bank_mask:0xf
  buffer_store_dwordx4 v[12:15], v70, s[8:11], s22 offen sc1
  buffer_store_dwordx4 v[16:19], v74, s[8:11], s22 offen sc1
  buffer_store_dwordx4 v[20:23], v71, s[8:11], s22 offen sc1
  buffer_store_dwordx4 v[24:27], v75, s[8:11], s22 offen sc1
  s_mov_b32 vcc_lo, 0xf0f0f0f
  s_mov_b32 vcc_hi, vcc_lo
  v_cndmask_b32_dpp v28, v52, v44, vcc row_ror:4 row_mask:0xf bank_mask:0xf
  v_cndmask_b32_dpp v29, v53, v45, vcc row_ror:4 row_mask:0xf bank_mask:0xf
  v_cndmask_b32_dpp v30, v54, v46, vcc row_ror:4 row_mask:0xf bank_mask:0xf
  v_cndmask_b32_dpp v31, v55, v47, vcc row_ror:4 row_mask:0xf bank_mask:0xf
  v_cndmask_b32_dpp v36, v56, v48, vcc row_ror:4 row_mask:0xf bank_mask:0xf
  v_cndmask_b32_dpp v37, v57, v49, vcc row_ror:4 row_mask:0xf bank_mask:0xf
  v_cndmask_b32_dpp v38, v58, v50, vcc row_ror:4 row_mask:0xf bank_mask:0xf
  v_cndmask_b32_dpp v39, v59, v51, vcc row_ror:4 row_mask:0xf bank_mask:0xf
  s_not_b64 vcc, vcc
  v_cndmask_b32_dpp v32, v44, v52, vcc row_ror:12 row_mask:0xf bank_mask:0xf
  v_cndmask_b32_dpp v33, v45, v53, vcc row_ror:12 row_mask:0xf bank_mask:0xf
  v_cndmask_b32_dpp v34, v46, v54, vcc row_ror:12 row_mask:0xf bank_mask:0xf
  v_cndmask_b32_dpp v35, v47, v55, vcc row_ror:12 row_mask:0xf bank_mask:0xf
  v_cndmask_b32_dpp v40, v48, v56, vcc row_ror:12 row_mask:0xf bank_mask:0xf
  v_cndmask_b32_dpp v41, v49, v57, vcc row_ror:12 row_mask:0xf bank_mask:0xf
  v_cndmask_b32_dpp v42, v50, v58, vcc row_ror:12 row_mask:0xf bank_mask:0xf
  v_cndmask_b32_dpp v43, v51, v59, vcc row_ror:12 row_mask:0xf bank_mask:0xf
  buffer_store_dwordx4 v[28:31], v68, s[8:11], s22 offen sc1
  buffer_store_dwordx4 v[32:35], v72, s[8:11], s22 offen sc1
  buffer_store_dwordx4 v[36:39], v69, s[8:11], s22 offen sc1
  buffer_store_dwordx4 v[40:43], v73, s[8:11], s22 offen sc1
  s_waitcnt vmcnt(0)
sent_main_16:
  s_cmp_eq_u32 s3, 0
  s_cbranch_scc1 w0_main_18
  s_mul_i32 s38, s2, 3
  s_add_u32 s38, s38, s3
  s_lshl_b32 s38, s38, 12
  s_add_u32 s38, s38, 26144768
  v_mov_b32 v12, -1
  v_mov_b32 v13, -1
  v_mov_b32 v14, -1
  v_mov_b32 v15, -1
  buffer_store_dwordx4 v[12:15], v2, s[8:11], s38 offen offset:0 sc1
  buffer_store_dwordx4 v[12:15], v2, s[8:11], s38 offen offset:1024 sc1
  buffer_store_dwordx4 v[12:15], v2, s[8:11], s38 offen offset:2048 sc1
  buffer_store_dwordx4 v[12:15], v2, s[8:11], s38 offen offset:3072 sc1
w0_main_18:
  v_mov_b32 v8, 1
  v_mov_b32 v9, 158880
  s_mov_b64 exec, 1
  s_waitcnt vmcnt(0)
  ds_add_rtn_u32 v10, v9, v8 offset:0
  s_waitcnt lgkmcnt(0)
  v_readfirstlane_b32 s38, v10
  s_cmp_lg_u32 s38, 3
  s_cbranch_scc1 ws_main_19
  s_lshl_b32 s38, s2, 7
  s_add_u32 s38, s38, 57344
  s_nop 0
  buffer_store_dword v8, v2, s[8:11], s38 offen sc1
ws_main_19:
  s_mov_b64 exec, -1
  s_mov_b32 s38, 0
aw_main_20:
  ds_read_b32 v10, v9
  s_add_u32 s38, s38, 1
  s_waitcnt lgkmcnt(0)
  v_readfirstlane_b32 s39, v10
  s_cmp_ge_u32 s39, 4
  s_cbranch_scc1 ag_main_21
  s_sleep 4
  s_cmp_lt_u32 s38, 1048576
  s_cbranch_scc1 aw_main_20
ag_main_21:
  s_branch KB_main_3
C_main_2:
  s_sub_u32 s3, s3, 4
  s_lshl_b32 s22, s7, 3
  s_add_u32 s22, s22, s3
  s_mul_i32 s23, s22, 36864
  s_add_u32 s23, s23, 155648
  v_lshlrev_b32 v5, 2, v4
  v_add_u32 v6, 77824, v2
  v_add_u32 v7, 143360, v2
  s_waitcnt lgkmcnt(0)
  s_mov_b32 s8, s4
  s_mov_b32 s9, s5
  s_mov_b32 s10, 0x2df0000
  s_mov_b32 s11, 0x20000
  s_barrier
  buffer_load_dwordx4 v[132:135], v2, s[8:11], s23 offen offset:0
  buffer_load_dwordx4 v[136:139], v2, s[8:11], s23 offen offset:1024
  buffer_load_dwordx4 v[140:143], v2, s[8:11], s23 offen offset:2048
  s_barrier
  ds_read_b128 v[92:95], v6 offset:0
  ds_read_b128 v[96:99], v6 offset:1024
  ds_read_b128 v[100:103], v6 offset:2048
  ds_read_b128 v[104:107], v6 offset:3072
  ds_read_b128 v[108:111], v6 offset:4096
  ds_read_b128 v[112:115], v6 offset:5120
  ds_read_b128 v[116:119], v6 offset:6144
  ds_read_b128 v[120:123], v6 offset:7168
  buffer_load_dwordx4 v[144:147], v2, s[8:11], s23 offen offset:3072
  s_add_u32 s23, s23, 4096
  buffer_load_dwordx4 v[148:151], v2, s[8:11], s23 offen offset:0
  s_waitcnt vmcnt(4) lgkmcnt(6)
  v_mfma_f32_32x32x16_bf16 v[32:47], v[132:135], v[96:99], 0
  v_mfma_f32_32x32x16_bf16 v[16:31], v[92:95], v[132:135], 0
  v_mov_b32 v8, v2
  v_mul_u32_u24 v9, 304, v3
  v_lshl_add_u32 v9, v4, 4, v9
  s_barrier
  ds_read_b128 v[92:95], v6 offset:8192
  ds_read_b128 v[96:99], v6 offset:9216
  buffer_load_dwordx4 v[152:155], v2, s[8:11], s23 offen offset:1024
  buffer_load_dwordx4 v[156:159], v2, s[8:11], s23 offen offset:2048
  s_waitcnt vmcnt(5) lgkmcnt(6)
  v_mfma_f32_32x32x16_bf16 v[32:47], v[136:139], v[104:107], v[32:47]
  v_mfma_f32_32x32x16_bf16 v[16:31], v[100:103], v[136:139], v[16:31]
  v_mov_b32 v10, 0x100000
  v_cmp_gt_u32 vcc, 19, v4
  s_nop 1
  v_cndmask_b32 v9, v10, v9, vcc
  ds_read_b128 v[100:103], v6 offset:10240
  ds_read_b128 v[104:107], v6 offset:11264
  buffer_load_dwordx4 v[160:163], v2, s[8:11], s23 offen offset:3072
  s_add_u32 s23, s23, 4096
  buffer_load_dwordx4 v[164:167], v2, s[8:11], s23 offen offset:0
  s_waitcnt vmcnt(6) lgkmcnt(6)
  v_mfma_f32_32x32x16_bf16 v[32:47], v[140:143], v[112:115], v[32:47]
  v_mfma_f32_32x32x16_bf16 v[16:31], v[108:111], v[140:143], v[16:31]
  v_lshl_add_u32 v10, v3, 8, v5
  v_add_u32 v10, 17920, v10
  v_mov_b32 v129, 158724
  ds_read_b128 v[108:111], v6 offset:12288
  ds_read_b128 v[112:115], v6 offset:13312
  buffer_load_dwordx4 v[132:135], v2, s[8:11], s23 offen offset:1024
  s_waitcnt vmcnt(6) lgkmcnt(6)
  v_mfma_f32_32x32x16_bf16 v[32:47], v[144:147], v[120:123], v[32:47]
  v_mfma_f32_32x32x16_bf16 v[16:31], v[116:119], v[144:147], v[16:31]
  v_mov_b32 v48, 0
  v_mov_b32 v49, 0
  v_mov_b32 v50, 0
  ds_read_b128 v[116:119], v6 offset:14336
  ds_read_b128 v[120:123], v6 offset:15360
  buffer_load_dwordx4 v[136:139], v2, s[8:11], s23 offen offset:2048
  s_waitcnt vmcnt(6) lgkmcnt(6)
  v_mfma_f32_32x32x16_bf16 v[32:47], v[148:151], v[96:99], v[32:47]
  v_mfma_f32_32x32x16_bf16 v[16:31], v[92:95], v[148:151], v[16:31]
  v_mov_b32 v51, 0
  v_mov_b32 v52, 0
  v_mov_b32 v53, 0
  s_barrier
  ds_read_b128 v[92:95], v6 offset:16384
  ds_read_b128 v[96:99], v6 offset:17408
  buffer_load_dwordx4 v[140:143], v2, s[8:11], s23 offen offset:3072
  s_add_u32 s23, s23, 4096
  s_waitcnt vmcnt(6) lgkmcnt(6)
  v_mfma_f32_32x32x16_bf16 v[32:47], v[152:155], v[104:107], v[32:47]
  v_mfma_f32_32x32x16_bf16 v[16:31], v[100:103], v[152:155], v[16:31]
  v_mov_b32 v54, 0
  v_mov_b32 v55, 0
  v_mov_b32 v56, 0
  ds_read_b128 v[100:103], v6 offset:18432
  ds_read_b128 v[104:107], v6 offset:19456
  buffer_load_dwordx4 v[144:147], v2, s[8:11], s23 offen offset:0
  s_waitcnt vmcnt(6) lgkmcnt(6)
  v_mfma_f32_32x32x16_bf16 v[32:47], v[156:159], v[112:115], v[32:47]
  v_mfma_f32_32x32x16_bf16 v[16:31], v[108:111], v[156:159], v[16:31]
  v_mov_b32 v57, 0
  v_mov_b32 v58, 0
  v_mov_b32 v59, 0
  ds_read_b128 v[108:111], v6 offset:20480
  ds_read_b128 v[112:115], v6 offset:21504
  buffer_load_dwordx4 v[148:151], v2, s[8:11], s23 offen offset:1024
  s_waitcnt vmcnt(6) lgkmcnt(6)
  v_mfma_f32_32x32x16_bf16 v[32:47], v[160:163], v[120:123], v[32:47]
  v_mfma_f32_32x32x16_bf16 v[16:31], v[116:119], v[160:163], v[16:31]
  v_mov_b32 v60, 0
  v_mov_b32 v61, 0
  v_mov_b32 v62, 0
  ds_read_b128 v[116:119], v6 offset:22528
  ds_read_b128 v[120:123], v6 offset:23552
  buffer_load_dwordx4 v[152:155], v2, s[8:11], s23 offen offset:2048
  s_waitcnt vmcnt(6) lgkmcnt(6)
  v_mfma_f32_32x32x16_bf16 v[32:47], v[164:167], v[96:99], v[32:47]
  v_mfma_f32_32x32x16_bf16 v[16:31], v[92:95], v[164:167], v[16:31]
  v_mov_b32 v63, 0
  v_mov_b32 v124, 0
  v_mov_b32 v125, 0
  ds_read_b128 v[92:95], v6 offset:24576
  ds_read_b128 v[96:99], v6 offset:25600
  buffer_load_dwordx4 v[156:159], v2, s[8:11], s23 offen offset:3072
  s_add_u32 s23, s23, 4096
  s_waitcnt vmcnt(6) lgkmcnt(6)
  v_mfma_f32_32x32x16_bf16 v[32:47], v[132:135], v[104:107], v[32:47]
  v_mfma_f32_32x32x16_bf16 v[16:31], v[100:103], v[132:135], v[16:31]
  v_mov_b32 v126, 0
  v_mov_b32 v127, 0
  v_mov_b32 v64, 0
  ds_read_b128 v[100:103], v6 offset:26624
  ds_read_b128 v[104:107], v6 offset:27648
  buffer_load_dwordx4 v[160:163], v2, s[8:11], s23 offen offset:0
  s_waitcnt vmcnt(6) lgkmcnt(6)
  v_mfma_f32_32x32x16_bf16 v[32:47], v[136:139], v[112:115], v[32:47]
  v_mfma_f32_32x32x16_bf16 v[16:31], v[108:111], v[136:139], v[16:31]
  v_mov_b32 v65, 0
  v_mov_b32 v66, 0
  v_mov_b32 v67, 0
  ds_read_b128 v[108:111], v6 offset:28672
  ds_read_b128 v[112:115], v6 offset:29696
  buffer_load_dwordx4 v[164:167], v2, s[8:11], s23 offen offset:1024
  s_waitcnt vmcnt(6) lgkmcnt(6)
  v_mfma_f32_32x32x16_bf16 v[32:47], v[140:143], v[120:123], v[32:47]
  v_mfma_f32_32x32x16_bf16 v[16:31], v[116:119], v[140:143], v[16:31]
  v_mov_b32 v68, 0
  v_mov_b32 v69, 0
  v_mov_b32 v70, 0
  ds_read_b128 v[116:119], v6 offset:30720
  ds_read_b128 v[120:123], v6 offset:31744
  buffer_load_dwordx4 v[132:135], v2, s[8:11], s23 offen offset:2048
  s_waitcnt vmcnt(6) lgkmcnt(6)
  v_mfma_f32_32x32x16_bf16 v[32:47], v[144:147], v[96:99], v[32:47]
  v_mfma_f32_32x32x16_bf16 v[16:31], v[92:95], v[144:147], v[16:31]
  v_mov_b32 v71, 0
  v_mov_b32 v72, 0
  v_mov_b32 v73, 0
  s_barrier
  ds_read_b128 v[92:95], v6 offset:32768
  ds_read_b128 v[96:99], v6 offset:33792
  buffer_load_dwordx4 v[136:139], v2, s[8:11], s23 offen offset:3072
  s_add_u32 s23, s23, 4096
  s_waitcnt vmcnt(6) lgkmcnt(6)
  v_mfma_f32_32x32x16_bf16 v[32:47], v[148:151], v[104:107], v[32:47]
  v_mfma_f32_32x32x16_bf16 v[16:31], v[100:103], v[148:151], v[16:31]
  v_mov_b32 v74, 0
  v_mov_b32 v75, 0
  v_mov_b32 v76, 0
  ds_read_b128 v[100:103], v6 offset:34816
  ds_read_b128 v[104:107], v6 offset:35840
  buffer_load_dwordx4 v[140:143], v2, s[8:11], s23 offen offset:0
  s_waitcnt vmcnt(6) lgkmcnt(6)
  v_mfma_f32_32x32x16_bf16 v[32:47], v[152:155], v[112:115], v[32:47]
  v_mfma_f32_32x32x16_bf16 v[16:31], v[108:111], v[152:155], v[16:31]
  v_mov_b32 v77, 0
  v_mov_b32 v78, 0
  v_mov_b32 v79, 0
  ds_read_b128 v[108:111], v6 offset:36864
  ds_read_b128 v[112:115], v6 offset:37888
  buffer_load_dwordx4 v[144:147], v2, s[8:11], s23 offen offset:1024
  s_waitcnt vmcnt(6) lgkmcnt(6)
  v_mfma_f32_32x32x16_bf16 v[32:47], v[156:159], v[120:123], v[32:47]
  v_mfma_f32_32x32x16_bf16 v[16:31], v[116:119], v[156:159], v[16:31]
  v_mov_b32 v130, 0x3f803f80
  v_mov_b32 v131, 0x3f803f80
  s_lshl_b32 s24, s3, 10
  ds_read_b128 v[116:119], v6 offset:38912
  ds_read_b128 v[120:123], v6 offset:39936
  buffer_load_dwordx4 v[148:151], v2, s[8:11], s23 offen offset:2048
  s_waitcnt vmcnt(6) lgkmcnt(6)
  v_mfma_f32_32x32x16_bf16 v[32:47], v[160:163], v[96:99], v[32:47]
  v_mfma_f32_32x32x16_bf16 v[16:31], v[92:95], v[160:163], v[16:31]
  v_add_u32 v11, s24, v2
  s_mul_i32 s24, s3, 1216
  s_add_u32 s24, s24, 8192
  ds_read_b128 v[92:95], v6 offset:40960
  ds_read_b128 v[96:99], v6 offset:41984
  buffer_load_dwordx4 v[152:155], v2, s[8:11], s23 offen offset:3072
  s_add_u32 s23, s23, 4096
  s_waitcnt vmcnt(6) lgkmcnt(6)
  v_mfma_f32_32x32x16_bf16 v[32:47], v[164:167], v[104:107], v[32:47]
  v_mfma_f32_32x32x16_bf16 v[16:31], v[100:103], v[164:167], v[16:31]
  v_add_u32 v12, s24, v9
  s_lshl_b32 s24, s3, 7
  v_mov_b32 v13, 157696
  ds_read_b128 v[100:103], v6 offset:43008
  ds_read_b128 v[104:107], v6 offset:44032
  buffer_load_dwordx4 v[156:159], v2, s[8:11], s23 offen offset:0
  s_waitcnt vmcnt(6) lgkmcnt(6)
  v_mfma_f32_32x32x16_bf16 v[32:47], v[132:135], v[112:115], v[32:47]
  v_mfma_f32_32x32x16_bf16 v[16:31], v[108:111], v[132:135], v[16:31]
  v_mov_b32 v14, 17920
  v_cmp_lt_u32 vcc, 21, v4
  s_nop 1
  v_cndmask_b32 v13, v13, v14, vcc
  ds_read_b128 v[108:111], v6 offset:45056
  ds_read_b128 v[112:115], v6 offset:46080
  buffer_load_dwordx4 v[160:163], v2, s[8:11], s23 offen offset:1024
  s_waitcnt vmcnt(6) lgkmcnt(6)
  v_mfma_f32_32x32x16_bf16 v[32:47], v[136:139], v[120:123], v[32:47]
  v_mfma_f32_32x32x16_bf16 v[16:31], v[116:119], v[136:139], v[16:31]
  v_lshl_add_u32 v13, v3, 4, v13
  v_and_b32 v14, 1, v4
  v_lshl_add_u32 v13, v14, 1, v13
  ds_read_b128 v[116:119], v6 offset:47104
  ds_read_b128 v[120:123], v6 offset:48128
  buffer_load_dwordx4 v[164:167], v2, s[8:11], s23 offen offset:2048
  s_waitcnt vmcnt(6) lgkmcnt(6)
  v_mfma_f32_32x32x16_bf16 v[32:47], v[140:143], v[96:99], v[32:47]
  v_mfma_f32_32x32x16_bf16 v[16:31], v[92:95], v[140:143], v[16:31]
  v_add_u32 v13, s24, v13
  v_mov_b32 v14, 0x3eae1a93
  v_and_b32 v15, 30, v4
  s_barrier
  ds_read_b128 v[92:95], v6 offset:49152
  ds_read_b128 v[96:99], v6 offset:50176
  buffer_load_dwordx4 v[132:135], v2, s[8:11], s23 offen offset:3072
  s_add_u32 s23, s23, 4096
  s_waitcnt vmcnt(6) lgkmcnt(6)
  v_mfma_f32_32x32x16_bf16 v[32:47], v[144:147], v[104:107], v[32:47]
  v_mfma_f32_32x32x16_bf16 v[16:31], v[100:103], v[144:147], v[16:31]
  v_cmp_eq_u32 vcc, 20, v15
  s_nop 1
  v_cndmask_b32 v14, 1.0, v14, vcc
  s_add_u32 s24, s24, 157696
  ds_read_b128 v[100:103], v6 offset:51200
  ds_read_b128 v[104:107], v6 offset:52224
  buffer_load_dwordx4 v[136:139], v2, s[8:11], s23 offen offset:0
  s_waitcnt vmcnt(6) lgkmcnt(6)
  v_mfma_f32_32x32x16_bf16 v[32:47], v[148:151], v[112:115], v[32:47]
  v_mfma_f32_32x32x16_bf16 v[16:31], v[108:111], v[148:151], v[16:31]
  v_add_u32 v84, s24, v5
  v_lshlrev_b32 v85, 3, v1
  v_add_u32 v85, 151552, v85
  ds_read_b128 v[108:111], v6 offset:53248
  ds_read_b128 v[112:115], v6 offset:54272
  buffer_load_dwordx4 v[140:143], v2, s[8:11], s23 offen offset:1024
  s_waitcnt vmcnt(6) lgkmcnt(6)
  v_mfma_f32_32x32x16_bf16 v[32:47], v[152:155], v[120:123], v[32:47]
  v_mfma_f32_32x32x16_bf16 v[16:31], v[116:119], v[152:155], v[16:31]
  s_mov_b32 s30, 0
  s_mov_b32 s16, 0x3eae1a93
  ds_read_b128 v[116:119], v6 offset:55296
  ds_read_b128 v[120:123], v6 offset:56320
  buffer_load_dwordx4 v[144:147], v2, s[8:11], s23 offen offset:2048
  s_waitcnt vmcnt(6) lgkmcnt(6)
  v_mfma_f32_32x32x16_bf16 v[32:47], v[156:159], v[96:99], v[32:47]
  v_mfma_f32_32x32x16_bf16 v[16:31], v[92:95], v[156:159], v[16:31]
  ds_read_b128 v[92:95], v6 offset:57344
  ds_read_b128 v[96:99], v6 offset:58368
  buffer_load_dwordx4 v[148:151], v2, s[8:11], s23 offen offset:3072
  s_add_u32 s23, s23, 4096
  s_waitcnt vmcnt(6) lgkmcnt(6)
  v_mfma_f32_32x32x16_bf16 v[32:47], v[160:163], v[104:107], v[32:47]
  v_mfma_f32_32x32x16_bf16 v[16:31], v[100:103], v[160:163], v[16:31]
  ds_read_b128 v[100:103], v6 offset:59392
  ds_read_b128 v[104:107], v6 offset:60416
  buffer_load_dwordx4 v[152:155], v2, s[8:11], s23 offen offset:0
  s_waitcnt vmcnt(6) lgkmcnt(6)
  v_mfma_f32_32x32x16_bf16 v[32:47], v[164:167], v[112:115], v[32:47]
  v_mfma_f32_32x32x16_bf16 v[16:31], v[108:111], v[164:167], v[16:31]
  ds_read_b128 v[108:111], v6 offset:61440
  ds_read_b128 v[112:115], v6 offset:62464
  buffer_load_dwordx4 v[156:159], v2, s[8:11], s23 offen offset:1024
  s_waitcnt vmcnt(6) lgkmcnt(6)
  v_mfma_f32_32x32x16_bf16 v[32:47], v[132:135], v[120:123], v[32:47]
  v_mfma_f32_32x32x16_bf16 v[16:31], v[116:119], v[132:135], v[16:31]
  ds_read_b128 v[116:119], v6 offset:63488
  ds_read_b128 v[120:123], v6 offset:64512
  buffer_load_dwordx4 v[160:163], v2, s[8:11], s23 offen offset:2048
  s_waitcnt vmcnt(6) lgkmcnt(6)
  v_mfma_f32_32x32x16_bf16 v[32:47], v[136:139], v[96:99], v[32:47]
  v_mfma_f32_32x32x16_bf16 v[16:31], v[92:95], v[136:139], v[16:31]
  ds_read_b128 v[92:95], v7 offset:0
  ds_read_b128 v[96:99], v7 offset:1024
  buffer_load_dwordx4 v[164:167], v2, s[8:11], s23 offen offset:3072
  s_waitcnt vmcnt(6) lgkmcnt(6)
  v_mfma_f32_32x32x16_bf16 v[32:47], v[140:143], v[104:107], v[32:47]
  v_mfma_f32_32x32x16_bf16 v[16:31], v[100:103], v[140:143], v[16:31]
  ds_read_b128 v[100:103], v7 offset:2048
  ds_read_b128 v[104:107], v7 offset:3072
  s_waitcnt vmcnt(5) lgkmcnt(6)
  v_mfma_f32_32x32x16_bf16 v[32:47], v[144:147], v[112:115], v[32:47]
  v_mfma_f32_32x32x16_bf16 v[16:31], v[108:111], v[144:147], v[16:31]
  ds_read_b128 v[108:111], v7 offset:4096
  ds_read_b128 v[112:115], v7 offset:5120
  s_waitcnt vmcnt(4) lgkmcnt(6)
  v_mfma_f32_32x32x16_bf16 v[32:47], v[148:151], v[120:123], v[32:47]
  v_mfma_f32_32x32x16_bf16 v[16:31], v[116:119], v[148:151], v[16:31]
  ds_read_b128 v[116:119], v7 offset:6144
  ds_read_b128 v[120:123], v7 offset:7168
  s_waitcnt vmcnt(3) lgkmcnt(6)
  v_mfma_f32_32x32x16_bf16 v[32:47], v[152:155], v[96:99], v[32:47]
  v_mfma_f32_32x32x16_bf16 v[16:31], v[92:95], v[152:155], v[16:31]
  ds_read_b64 v[92:93], v85
  ds_read_b64 v[96:97], v85 offset:512
  s_waitcnt vmcnt(2) lgkmcnt(6)
  v_mfma_f32_32x32x16_bf16 v[32:47], v[156:159], v[104:107], v[32:47]
  v_mfma_f32_32x32x16_bf16 v[16:31], v[100:103], v[156:159], v[16:31]
  s_waitcnt vmcnt(1) lgkmcnt(4)
  v_mfma_f32_32x32x16_bf16 v[32:47], v[160:163], v[112:115], v[32:47]
  v_mfma_f32_32x32x16_bf16 v[16:31], v[108:111], v[160:163], v[16:31]
  s_waitcnt vmcnt(0) lgkmcnt(2)
  v_mfma_f32_32x32x16_bf16 v[32:47], v[164:167], v[120:123], v[32:47]
  v_mfma_f32_32x32x16_bf16 v[16:31], v[116:119], v[164:167], v[16:31]
  s_waitcnt lgkmcnt(0)
  s_nop 7
  v_mfma_f32_32x32x8_bf16 v[32:47], v[130:131], v[96:97], v[32:47]
  v_mfma_f32_32x32x8_bf16 v[16:31], v[92:93], v[130:131], v[16:31]
  s_nop 10
  v_mul_f32 v32, v14, v32
  v_mul_f32 v33, v14, v33
  v_mul_f32 v34, v14, v34
  v_mul_f32 v35, v14, v35
  v_mul_f32 v36, v14, v36
  v_mul_f32 v37, v14, v37
  v_mul_f32 v38, v14, v38
  v_mul_f32 v39, v14, v39
  v_mul_f32 v40, v14, v40
  v_mul_f32 v41, v14, v41
  v_mul_f32 v42, v14, v42
  v_mul_f32 v43, v14, v43
  v_mul_f32 v44, v14, v44
  v_mul_f32 v45, v14, v45
  v_mul_f32 v46, v14, v46
  v_mul_f32 v47, v14, v47
  v_cvt_pk_bf16_f32 v132, v32, v33
  v_cvt_pk_bf16_f32 v133, v34, v35
  v_cvt_pk_bf16_f32 v134, v36, v37
  v_cvt_pk_bf16_f32 v135, v38, v39
  v_cvt_pk_bf16_f32 v136, v40, v41
  v_cvt_pk_bf16_f32 v137, v42, v43
  v_cvt_pk_bf16_f32 v138, v44, v45
  v_cvt_pk_bf16_f32 v139, v46, v47
  ds_write_b128 v12, v[132:135]
  ds_write_b128 v12, v[136:139] offset:608
  v_cvt_pk_bf16_f32 v140, v24, v25
  v_cvt_pk_bf16_f32 v141, v26, v27
  v_cvt_pk_bf16_f32 v142, v28, v29
  v_cvt_pk_bf16_f32 v143, v30, v31
  ds_write_b128 v11, v[140:143]
  s_mov_b32 exec_lo, 0xf00000
  s_mov_b32 exec_hi, 0xf00000
  ds_write_b16 v13, v132 offset:0
  ds_write_b16_d16_hi v13, v132 offset:4
  ds_write_b16 v13, v133 offset:8
  ds_write_b16_d16_hi v13, v133 offset:12
  ds_write_b16 v13, v134 offset:32
  ds_write_b16_d16_hi v13, v134 offset:36
  ds_write_b16 v13, v135 offset:40
  ds_write_b16_d16_hi v13, v135 offset:44
  ds_write_b16 v13, v136 offset:64
  ds_write_b16_d16_hi v13, v136 offset:68
  ds_write_b16 v13, v137 offset:72
  ds_write_b16_d16_hi v13, v137 offset:76
  ds_write_b16 v13, v138 offset:96
  ds_write_b16_d16_hi v13, v138 offset:100
  ds_write_b16 v13, v139 offset:104
  ds_write_b16_d16_hi v13, v139 offset:108
  s_mov_b64 exec, -1
  ds_read_b32 v6, v84
  v_mul_f32 v16, s16, v16
  v_mul_f32 v17, s16, v17
  v_mul_f32 v18, s16, v18
  v_mul_f32 v19, s16, v19
  v_mul_f32 v20, s16, v20
  v_mul_f32 v21, s16, v21
  v_mul_f32 v22, s16, v22
  v_mul_f32 v23, s16, v23
  v_cvt_pk_bf16_f32 v80, v16, v17
  v_cvt_pk_bf16_f32 v81, v18, v19
  v_cvt_pk_bf16_f32 v82, v20, v21
  v_cvt_pk_bf16_f32 v83, v22, v23
  s_setprio 2
  s_waitcnt lgkmcnt(0)
  s_barrier
  v_cmp_gt_u32 vcc, 32, v1
  s_nop 1
  v_cndmask_b32 v84, 0, v6, vcc
  v_mov_b32 v85, 0
  v_mov_b32 v86, 0
  v_cndmask_b32 v87, 0, v6, vcc
  v_cndmask_b32 v88, v6, 0, vcc
  v_mov_b32 v89, 0
  v_mov_b32 v90, 0
  v_cndmask_b32 v91, v6, 0, vcc
pass_main_22:
  ds_read_b128 v[92:95], v8
  ds_read2_b32 v[116:117], v10 offset0:0 offset1:32
  ds_read_b128 v[96:99], v8 offset:1024
  ds_read_b128 v[100:103], v9 offset:8192
  ds_read_b128 v[104:107], v9 offset:8800
  v_mov_b32 v112, 0
  v_mov_b32 v113, 0
  v_mov_b32 v114, 0
  v_mov_b32 v115, 0
  s_mov_b32 s31, s30
  s_add_u32 s29, s30, 8
  s_mov_b32 s28, 0
  s_mov_b32 s27, 104
  s_waitcnt lgkmcnt(3)
  v_mfma_f32_32x32x16_bf16 v[16:31], v[92:95], v[80:83], v[64:79]
  s_nop 9
  v_mfma_f32_32x32x8_bf16 v[16:31], v[116:117], v[84:85], v[16:31]
  s_nop 9
  .p2align 6
loop_main_23:
  s_waitcnt lgkmcnt(0)
  v_mfma_f32_32x32x16_bf16 v[32:47], v[96:99], v[80:83], v[64:79]
  ds_read_b128 v[92:95], v8 offset:2048
  ds_read_b128 v[108:111], v9 offset:9408
  v_exp_f32 v16, v16
  v_exp_f32 v17, v17
  v_exp_f32 v18, v18
  v_exp_f32 v19, v19
  v_mfma_f32_32x32x16_bf16 v[48:63], v[112:115], v[124:127], v[48:63]
  ds_read_b128 v[112:115], v9 offset:10016
  ds_read2_b32 v[118:119], v10 offset0:128 offset1:160
  v_exp_f32 v20, v20
  v_exp_f32 v21, v21
  v_exp_f32 v22, v22
  v_exp_f32 v23, v23
  v_mfma_f32_32x32x8_bf16 v[32:47], v[116:117], v[86:87], v[32:47]
  v_cvt_pk_bf16_f32 v120, v16, v17
  v_cvt_pk_bf16_f32 v121, v18, v19
  v_cvt_pk_bf16_f32 v122, v20, v21
  v_cvt_pk_bf16_f32 v123, v22, v23
  v_exp_f32 v24, v24
  v_exp_f32 v25, v25
  v_mfma_f32_32x32x16_bf16 v[48:63], v[100:103], v[120:123], v[48:63]
  v_exp_f32 v26, v26
  v_exp_f32 v27, v27
  v_exp_f32 v28, v28
  v_exp_f32 v29, v29
  v_exp_f32 v30, v30
  v_exp_f32 v31, v31
  v_cvt_pk_bf16_f32 v124, v24, v25
  v_cvt_pk_bf16_f32 v125, v26, v27
  v_cvt_pk_bf16_f32 v126, v28, v29
  v_cvt_pk_bf16_f32 v127, v30, v31
  s_waitcnt lgkmcnt(0)
  v_mfma_f32_32x32x16_bf16 v[16:31], v[92:95], v[80:83], v[64:79]
  ds_read_b128 v[96:99], v8 offset:3072
  ds_read_b128 v[100:103], v9 offset:10624
  v_exp_f32 v32, v32
  v_exp_f32 v33, v33
  v_exp_f32 v34, v34
  v_exp_f32 v35, v35
  v_mfma_f32_32x32x16_bf16 v[48:63], v[104:107], v[124:127], v[48:63]
  ds_read_b128 v[104:107], v9 offset:11232
  v_exp_f32 v36, v36
  v_exp_f32 v37, v37
  v_exp_f32 v38, v38
  v_exp_f32 v39, v39
  v_mfma_f32_32x32x8_bf16 v[16:31], v[116:117], v[88:89], v[16:31]
  v_cvt_pk_bf16_f32 v120, v32, v33
  v_cvt_pk_bf16_f32 v121, v34, v35
  v_cvt_pk_bf16_f32 v122, v36, v37
  v_cvt_pk_bf16_f32 v123, v38, v39
  v_exp_f32 v40, v40
  v_exp_f32 v41, v41
  v_mfma_f32_32x32x16_bf16 v[48:63], v[108:111], v[120:123], v[48:63]
  v_exp_f32 v42, v42
  v_exp_f32 v43, v43
  v_exp_f32 v44, v44
  v_exp_f32 v45, v45
  v_exp_f32 v46, v46
  v_exp_f32 v47, v47
  v_cvt_pk_bf16_f32 v124, v40, v41
  v_cvt_pk_bf16_f32 v125, v42, v43
  v_cvt_pk_bf16_f32 v126, v44, v45
  v_cvt_pk_bf16_f32 v127, v46, v47
  s_waitcnt lgkmcnt(0)
  v_mfma_f32_32x32x16_bf16 v[32:47], v[96:99], v[80:83], v[64:79]
  ds_read_b128 v[92:95], v8 offset:4096
  ds_read_b128 v[108:111], v9 offset:11840
  v_exp_f32 v16, v16
  v_exp_f32 v17, v17
  v_exp_f32 v18, v18
  v_exp_f32 v19, v19
  v_mfma_f32_32x32x16_bf16 v[48:63], v[112:115], v[124:127], v[48:63]
  ds_read_b128 v[112:115], v9 offset:12448
  v_exp_f32 v20, v20
  v_exp_f32 v21, v21
  v_exp_f32 v22, v22
  v_exp_f32 v23, v23
  v_mfma_f32_32x32x8_bf16 v[32:47], v[116:117], v[90:91], v[32:47]
  v_cvt_pk_bf16_f32 v120, v16, v17
  v_cvt_pk_bf16_f32 v121, v18, v19
  v_cvt_pk_bf16_f32 v122, v20, v21
  v_cvt_pk_bf16_f32 v123, v22, v23
  v_exp_f32 v24, v24
  v_exp_f32 v25, v25
  v_mfma_f32_32x32x16_bf16 v[48:63], v[100:103], v[120:123], v[48:63]
  v_exp_f32 v26, v26
  v_exp_f32 v27, v27
  v_exp_f32 v28, v28
  v_exp_f32 v29, v29
  v_exp_f32 v30, v30
  v_exp_f32 v31, v31
  v_add_u32 v10, 19456, v10
  v_cvt_pk_bf16_f32 v124, v24, v25
  v_cvt_pk_bf16_f32 v125, v26, v27
  v_cvt_pk_bf16_f32 v126, v28, v29
  v_cvt_pk_bf16_f32 v127, v30, v31
  s_waitcnt lgkmcnt(0)
  v_mfma_f32_32x32x16_bf16 v[16:31], v[92:95], v[80:83], v[64:79]
  ds_read_b128 v[96:99], v8 offset:5120
  ds_read_b128 v[100:103], v9 offset:13056
  v_exp_f32 v32, v32
  v_exp_f32 v33, v33
  v_exp_f32 v34, v34
  v_exp_f32 v35, v35
  v_mfma_f32_32x32x16_bf16 v[48:63], v[104:107], v[124:127], v[48:63]
  ds_read_b128 v[104:107], v9 offset:13664
  v_exp_f32 v36, v36
  v_exp_f32 v37, v37
  v_exp_f32 v38, v38
  v_exp_f32 v39, v39
  v_mfma_f32_32x32x8_bf16 v[16:31], v[118:119], v[84:85], v[16:31]
  v_cvt_pk_bf16_f32 v120, v32, v33
  v_cvt_pk_bf16_f32 v121, v34, v35
  v_cvt_pk_bf16_f32 v122, v36, v37
  v_cvt_pk_bf16_f32 v123, v38, v39
  v_exp_f32 v40, v40
  v_exp_f32 v41, v41
  v_mfma_f32_32x32x16_bf16 v[48:63], v[108:111], v[120:123], v[48:63]
  v_exp_f32 v42, v42
  v_exp_f32 v43, v43
  v_exp_f32 v44, v44
  v_exp_f32 v45, v45
  v_exp_f32 v46, v46
  v_exp_f32 v47, v47
  v_cvt_pk_bf16_f32 v124, v40, v41
  v_cvt_pk_bf16_f32 v125, v42, v43
  v_cvt_pk_bf16_f32 v126, v44, v45
  v_cvt_pk_bf16_f32 v127, v46, v47
  s_waitcnt lgkmcnt(0)
  v_mfma_f32_32x32x16_bf16 v[32:47], v[96:99], v[80:83], v[64:79]
  ds_read_b128 v[92:95], v8 offset:6144
  ds_read_b128 v[108:111], v9 offset:14272
  v_exp_f32 v16, v16
  v_exp_f32 v17, v17
  v_exp_f32 v18, v18
  v_exp_f32 v19, v19
  v_mfma_f32_32x32x16_bf16 v[48:63], v[112:115], v[124:127], v[48:63]
  ds_read_b128 v[112:115], v9 offset:14880
  v_exp_f32 v20, v20
  v_exp_f32 v21, v21
  v_exp_f32 v22, v22
  v_exp_f32 v23, v23
  v_mfma_f32_32x32x8_bf16 v[32:47], v[118:119], v[86:87], v[32:47]
  v_cvt_pk_bf16_f32 v120, v16, v17
  v_cvt_pk_bf16_f32 v121, v18, v19
  v_cvt_pk_bf16_f32 v122, v20, v21
  v_cvt_pk_bf16_f32 v123, v22, v23
  v_exp_f32 v24, v24
  v_exp_f32 v25, v25
  v_mfma_f32_32x32x16_bf16 v[48:63], v[100:103], v[120:123], v[48:63]
  v_exp_f32 v26, v26
  v_exp_f32 v27, v27
  v_exp_f32 v28, v28
  v_exp_f32 v29, v29
  v_exp_f32 v30, v30
  v_exp_f32 v31, v31
  v_cvt_pk_bf16_f32 v124, v24, v25
  v_cvt_pk_bf16_f32 v125, v26, v27
  v_cvt_pk_bf16_f32 v126, v28, v29
  v_cvt_pk_bf16_f32 v127, v30, v31
  s_waitcnt lgkmcnt(0)
  v_mfma_f32_32x32x16_bf16 v[16:31], v[92:95], v[80:83], v[64:79]
  ds_read_b128 v[96:99], v8 offset:7168
  ds_read_b128 v[100:103], v9 offset:15488
  v_exp_f32 v32, v32
  v_exp_f32 v33, v33
  v_exp_f32 v34, v34
  v_exp_f32 v35, v35
  v_mfma_f32_32x32x16_bf16 v[48:63], v[104:107], v[124:127], v[48:63]
  ds_read_b128 v[104:107], v9 offset:16096
  ds_read_b32 v128, v129
  v_exp_f32 v36, v36
  v_exp_f32 v37, v37
  v_exp_f32 v38, v38
  v_exp_f32 v39, v39
  v_mfma_f32_32x32x8_bf16 v[16:31], v[118:119], v[88:89], v[16:31]
  v_cvt_pk_bf16_f32 v120, v32, v33
  v_cvt_pk_bf16_f32 v121, v34, v35
  v_cvt_pk_bf16_f32 v122, v36, v37
  v_cvt_pk_bf16_f32 v123, v38, v39
  v_exp_f32 v40, v40
  v_exp_f32 v41, v41
  v_mfma_f32_32x32x16_bf16 v[48:63], v[108:111], v[120:123], v[48:63]
  v_exp_f32 v42, v42
  v_exp_f32 v43, v43
  v_exp_f32 v44, v44
  v_exp_f32 v45, v45
  v_exp_f32 v46, v46
  v_exp_f32 v47, v47
  v_cvt_pk_bf16_f32 v124, v40, v41
  v_cvt_pk_bf16_f32 v125, v42, v43
  v_cvt_pk_bf16_f32 v126, v44, v45
  v_cvt_pk_bf16_f32 v127, v46, v47
  s_waitcnt lgkmcnt(0)
  v_readfirstlane_b32 s12, v128
  s_add_u32 s28, s28, 0x01010101
  s_sub_u32 s12, s12, s28
  s_or_b32 s12, s12, s27
  s_and_b32 s12, s12, 0x80808080
  s_cbranch_scc1 bar_main_24
barret_main_25:
  v_mfma_f32_32x32x16_bf16 v[32:47], v[96:99], v[80:83], v[64:79]
  ds_read_b128 v[92:95], v8 offset:19456
  ds_read_b128 v[108:111], v9 offset:16704
  v_exp_f32 v16, v16
  v_exp_f32 v17, v17
  v_exp_f32 v18, v18
  v_exp_f32 v19, v19
  v_mfma_f32_32x32x16_bf16 v[48:63], v[112:115], v[124:127], v[48:63]
  ds_read_b128 v[112:115], v9 offset:17312
  ds_read2_b32 v[116:117], v10 offset0:0 offset1:32
  v_exp_f32 v20, v20
  v_exp_f32 v21, v21
  v_exp_f32 v22, v22
  v_exp_f32 v23, v23
  v_mfma_f32_32x32x8_bf16 v[32:47], v[118:119], v[90:91], v[32:47]
  v_cvt_pk_bf16_f32 v120, v16, v17
  v_cvt_pk_bf16_f32 v121, v18, v19
  v_cvt_pk_bf16_f32 v122, v20, v21
  v_cvt_pk_bf16_f32 v123, v22, v23
  v_exp_f32 v24, v24
  v_exp_f32 v25, v25
  v_mfma_f32_32x32x16_bf16 v[48:63], v[100:103], v[120:123], v[48:63]
  v_exp_f32 v26, v26
  v_exp_f32 v27, v27
  v_exp_f32 v28, v28
  v_exp_f32 v29, v29
  v_exp_f32 v30, v30
  v_exp_f32 v31, v31
  v_cvt_pk_bf16_f32 v124, v24, v25
  v_cvt_pk_bf16_f32 v125, v26, v27
  v_cvt_pk_bf16_f32 v126, v28, v29
  v_cvt_pk_bf16_f32 v127, v30, v31
  s_waitcnt lgkmcnt(0)
  v_mfma_f32_32x32x16_bf16 v[16:31], v[92:95], v[80:83], v[64:79]
  ds_read_b128 v[96:99], v8 offset:20480
  ds_read_b128 v[100:103], v9 offset:27648
  v_exp_f32 v32, v32
  v_exp_f32 v33, v33
  v_exp_f32 v34, v34
  v_exp_f32 v35, v35
  v_mfma_f32_32x32x16_bf16 v[48:63], v[104:107], v[124:127], v[48:63]
  ds_read_b128 v[104:107], v9 offset:28256
  v_exp_f32 v36, v36
  v_exp_f32 v37, v37
  v_exp_f32 v38, v38
  v_exp_f32 v39, v39
  v_mfma_f32_32x32x8_bf16 v[16:31], v[116:117], v[84:85], v[16:31]
  v_cvt_pk_bf16_f32 v120, v32, v33
  v_cvt_pk_bf16_f32 v121, v34, v35
  v_cvt_pk_bf16_f32 v122, v36, v37
  v_cvt_pk_bf16_f32 v123, v38, v39
  v_exp_f32 v40, v40
  v_exp_f32 v41, v41
  v_mfma_f32_32x32x16_bf16 v[48:63], v[108:111], v[120:123], v[48:63]
  v_exp_f32 v42, v42
  v_exp_f32 v43, v43
  v_exp_f32 v44, v44
  v_exp_f32 v45, v45
  v_exp_f32 v46, v46
  v_exp_f32 v47, v47
  v_add_u32 v8, 19456, v8
  v_add_u32 v9, 19456, v9
  s_add_u32 s31, s31, 1
  s_add_u32 s27, s27, 4
  s_cmp_lt_u32 s31, s29
  v_cvt_pk_bf16_f32 v124, v40, v41
  v_cvt_pk_bf16_f32 v125, v42, v43
  v_cvt_pk_bf16_f32 v126, v44, v45
  v_cvt_pk_bf16_f32 v127, v46, v47
  s_cbranch_scc1 loop_main_23
  s_nop 0
  v_mfma_f32_32x32x16_bf16 v[48:63], v[112:115], v[124:127], v[48:63]
  s_waitcnt lgkmcnt(0)
  s_nop 10
  v_mov_b32 v11, v58
  v_mov_b32 v12, v58
  s_nop 1
  v_permlane32_swap_b32 v11, v12
  v_rcp_f32 v13, v11
  v_cmp_gt_u32 vcc, 32, v1
  s_nop 1
  v_cndmask_b32 v56, 0, v56, vcc
  v_cndmask_b32 v57, 0, v57, vcc
  v_mov_b32 v14, 0
  v_fma_f32 v14, v48, 0, v14
  v_fma_f32 v14, v49, 0, v14
  v_fma_f32 v14, v50, 0, v14
  v_fma_f32 v14, v51, 0, v14
  v_fma_f32 v14, v52, 0, v14
  v_fma_f32 v14, v53, 0, v14
  v_fma_f32 v14, v54, 0, v14
  v_fma_f32 v14, v55, 0, v14
  v_fma_f32 v14, v56, 0, v14
  v_fma_f32 v14, v57, 0, v14
  v_add_f32 v14, v14, v11
  v_cmp_nge_f32 vcc, 0x5d800000, v14
  v_mov_b32 v15, 0x21800000
  v_cmp_nle_f32 s[12:13], v15, v14
  s_or_b64 vcc, vcc, s[12:13]
  s_cbranch_vccnz fb_main_26
out_main_27:
  v_mul_f32 v48, v48, v13
  v_mul_f32 v49, v49, v13
  v_mul_f32 v50, v50, v13
  v_mul_f32 v51, v51, v13
  v_mul_f32 v52, v52, v13
  v_mul_f32 v53, v53, v13
  v_mul_f32 v54, v54, v13
  v_mul_f32 v55, v55, v13
  v_mul_f32 v56, v56, v13
  v_mul_f32 v57, v57, v13
  v_cvt_pk_bf16_f32 v16, v48, v49
  v_cvt_pk_bf16_f32 v17, v50, v51
  v_cvt_pk_bf16_f32 v18, v52, v53
  v_cvt_pk_bf16_f32 v19, v54, v55
  v_cvt_pk_bf16_f32 v20, v56, v57
  v_lshrrev_b32 v6, 4, v4
  v_mul_u32_u24 v6, 18432, v6
  v_and_b32 v7, 15, v4
  v_lshl_add_u32 v6, v7, 4, v6
  v_lshl_add_u32 v7, v3, 8, v6
  v_bfrev_b32 v11, 1
  v_cmp_gt_u32 vcc, 32, v1
  s_nop 1
  v_cndmask_b32 v6, v11, v5, vcc
  s_mul_i32 s12, s22, 36864
  s_add_u32 s12, s12, 12214272
  s_lshl_b32 s13, s6, 9
  s_add_u32 s13, s13, s12
  s_lshr_b32 s14, s6, 4
  s_mul_i32 s14, s14, 18432
  s_and_b32 s15, s6, 15
  s_lshl_b32 s15, s15, 7
  s_add_u32 s14, s14, s15
  s_add_u32 s14, s14, s12
  s_add_u32 s14, s14, 16384
  buffer_store_dwordx4 v[16:19], v7, s[8:11], s13 offen sc1
  buffer_store_dword v20, v6, s[8:11], s14 offen sc1
  s_add_u32 s3, s3, 4
  s_branch KB_main_3
bar_main_24:
  s_mov_b32 s13, 0
sp_main_28:
  v_readfirstlane_b32 s12, v128
  s_add_u32 s13, s13, 1
  s_sub_u32 s12, s12, s28
  s_and_b32 s12, s12, 0x80808080
  s_cbranch_scc0 ok_main_29
  s_sleep 1
  ds_read_b32 v128, v129
  s_cmp_lt_u32 s13, 16777216
  s_waitcnt lgkmcnt(0)
  s_cbranch_scc1 sp_main_28
ok_main_29:
  s_cmp_lt_u32 s27, 128
  s_cbranch_scc1 barret_main_25
  s_setprio 1
  s_cmp_eq_u32 s27, 128
  s_cbranch_scc1 barret_main_25
  s_setprio 3
  s_branch barret_main_25
fb_main_26:
  s_cmp_lg_u32 s30, 0
  s_cbranch_scc1 out_main_27
  s_mov_b32 s30, 8
  v_mov_b32 v11, 0xff800000
  v_mov_b32 v117, 0
  s_mov_b32 s31, 0
mx_main_31:
  s_lshr_b32 s12, s31, 3
  s_mul_i32 s12, s12, 19456
  s_and_b32 s13, s31, 7
  s_lshl_b32 s14, s13, 10
  s_add_u32 s14, s14, s12
  s_lshl_b32 s13, s13, 7
  s_add_u32 s13, s13, s12
  s_add_u32 s13, s13, 17920
  v_add_u32 v8, s14, v2
  v_add_u32 v10, s13, v5
  ds_read_b128 v[92:95], v8
  ds_read_b32 v116, v10
  s_waitcnt lgkmcnt(0)
  v_mfma_f32_32x32x16_bf16 v[16:31], v[92:95], v[80:83], 0
  s_nop 9
  v_mfma_f32_32x32x8_bf16 v[16:31], v[116:117], v[84:85], v[16:31]
  s_nop 11
  v_max3_f32 v11, v11, v16, v17
  v_max3_f32 v11, v11, v18, v19
  v_max3_f32 v11, v11, v20, v21
  v_max3_f32 v11, v11, v22, v23
  v_max3_f32 v11, v11, v24, v25
  v_max3_f32 v11, v11, v26, v27
  v_max3_f32 v11, v11, v28, v29
  v_max3_f32 v11, v11, v30, v31
  s_add_u32 s31, s31, 1
  s_cmp_lt_u32 s31, 64
  s_cbranch_scc1 mx_main_31
  v_mov_b32 v12, v11
  s_nop 1
  v_permlane32_swap_b32 v11, v12
  v_max_f32 v11, v11, v12
  v_sub_f32 v64, 0, v11
  v_sub_f32 v65, 0, v11
  v_sub_f32 v66, 0, v11
  v_sub_f32 v67, 0, v11
  v_sub_f32 v68, 0, v11
  v_sub_f32 v69, 0, v11
  v_sub_f32 v70, 0, v11
  v_sub_f32 v71, 0, v11
  v_sub_f32 v72, 0, v11
  v_sub_f32 v73, 0, v11
  v_sub_f32 v74, 0, v11
  v_sub_f32 v75, 0, v11
  v_sub_f32 v76, 0, v11
  v_sub_f32 v77, 0, v11
  v_sub_f32 v78, 0, v11
  v_sub_f32 v79, 0, v11
  v_mov_b32 v8, v2
  v_mul_u32_u24 v9, 304, v3
  v_lshl_add_u32 v9, v4, 4, v9
  v_mov_b32 v10, 0x100000
  v_cmp_gt_u32 vcc, 19, v4
  s_nop 1
  v_cndmask_b32 v9, v10, v9, vcc
  v_lshl_add_u32 v10, v3, 8, v5
  v_add_u32 v10, 17920, v10
  v_mov_b32 v129, 158724
  v_mov_b32 v48, 0
  v_mov_b32 v49, 0
  v_mov_b32 v50, 0
  v_mov_b32 v51, 0
  v_mov_b32 v52, 0
  v_mov_b32 v53, 0
  v_mov_b32 v54, 0
  v_mov_b32 v55, 0
  v_mov_b32 v56, 0
  v_mov_b32 v57, 0
  v_mov_b32 v58, 0
  v_mov_b32 v59, 0
  v_mov_b32 v60, 0
  v_mov_b32 v61, 0
  v_mov_b32 v62, 0
  v_mov_b32 v63, 0
  v_mov_b32 v124, 0
  v_mov_b32 v125, 0
  v_mov_b32 v126, 0
  v_mov_b32 v127, 0
  s_branch pass_main_22
KB_main_3:
  s_load_dwordx2 s[6:7], s[0:1], 0
  s_load_dwordx2 s[30:31], s[0:1], 64
  v_mov_b32 v165, 158784
  ds_read_b32 v166, v165 offset:88
  s_cmp_ge_u32 s3, 4
  s_cselect_b32 s32, 1, 0
  v_mov_b32 v8, s32
  v_add_u32 v9, s3, v165
  ds_write_b8 v9, v8 offset:108
  v_and_b32 v1, 63, v0
  s_and_b32 s20, s2, 3
  s_lshl_b32 s20, s20, 1
  s_bfe_u32 s21, s2, 0x10003
  s_add_u32 s20, s20, s21
  s_and_b32 s21, s2, 7
  s_lshr_b32 s21, s21, 2
  s_lshl_b32 s21, s21, 4
  s_lshr_b32 s22, s2, 4
  s_add_u32 s21, s21, s22
  s_lshr_b32 s22, s3, 2
  s_and_b32 s23, s3, 3
  s_lshr_b32 s24, s20, 2
  s_lshl1_add_u32 s24, s21, s24
  s_add_u32 s28, s22, 1
  s_cmp_eq_u32 s23, 3
  s_cselect_b32 s29, 2, s22
  s_cselect_b32 s28, s28, s23
  s_and_b32 s25, s20, 3
  s_mul_i32 s25, s25, 3
  s_add_u32 s25, s25, s29
  s_mul_i32 s29, s25, 55296
  s_lshl_b32 s32, s28, 10
  s_add_u32 s29, s29, s32
  s_add_u32 s29, s29, 14573568
  s_mul_i32 s25, s25, 3
  s_add_u32 s25, s25, s28
  s_mul_i32 s26, s20, 12
  s_add_u32 s27, s26, s22
  s_add_u32 s26, s26, s3
  s_mul_i32 s26, s26, 58368
  s_add_u32 s26, s26, 15237120
  s_mul_i32 s33, s23, 3
  s_add_u32 s27, s27, s33
  s_mul_i32 s27, s27, 55296
  s_add_u32 s27, s27, 20840448
  v_add_u32 v7, 0x10000, v2
  v_add_u32 v3, 0x20000, v2
  v_bfrev_b32 v167, 1
  v_cmp_gt_u32 vcc, 48, v1
  v_and_b32 v4, 15, v1
  v_lshlrev_b32 v4, 3, v4
  v_sub_u32 v4, v2, v4
  v_cndmask_b32 v167, v167, v4, vcc
  s_waitcnt lgkmcnt(0)
  s_mov_b32 s42, 0
  v_bfrev_b32 v164, 1
  s_mov_b32 s36, 0
  s_mov_b32 s37, 0
  s_cmp_gt_u32 s3, 8
  s_cbranch_scc1 og_main_37
  s_cmp_lg_u32 s22, 1
  s_cbranch_scc1 ta_main_39
  buffer_load_dwordx4 v[16:19], v2, s[8:11], s29 offen
  s_add_u32 s29, s29, 3072
  buffer_load_dwordx4 v[20:23], v2, s[8:11], s29 offen
  s_add_u32 s29, s29, 3072
  buffer_load_dwordx4 v[24:27], v2, s[8:11], s29 offen
  s_add_u32 s29, s29, 3072
  buffer_load_dwordx4 v[28:31], v2, s[8:11], s29 offen
  s_add_u32 s29, s29, 3072
  buffer_load_dwordx4 v[32:35], v2, s[8:11], s29 offen
  s_add_u32 s29, s29, 3072
  buffer_load_dwordx4 v[36:39], v2, s[8:11], s29 offen
  s_add_u32 s29, s29, 3072
  s_waitcnt vmcnt(5)
  buffer_load_dwordx4 v[40:43], v2, s[8:11], s29 offen
  s_add_u32 s29, s29, 3072
  s_waitcnt vmcnt(5)
  buffer_load_dwordx4 v[44:47], v2, s[8:11], s29 offen
  s_add_u32 s29, s29, 3072
  s_waitcnt vmcnt(5)
  buffer_load_dwordx4 v[48:51], v2, s[8:11], s29 offen
  s_add_u32 s29, s29, 3072
  s_waitcnt vmcnt(5)
  buffer_load_dwordx4 v[52:55], v2, s[8:11], s29 offen
  s_add_u32 s29, s29, 3072
  s_waitcnt vmcnt(5)
  buffer_load_dwordx4 v[56:59], v2, s[8:11], s29 offen
  s_add_u32 s29, s29, 3072
  s_waitcnt vmcnt(5)
  buffer_load_dwordx4 v[60:63], v2, s[8:11], s29 offen
  s_add_u32 s29, s29, 3072
  s_waitcnt vmcnt(5)
  buffer_load_dwordx4 v[64:67], v2, s[8:11], s29 offen
  s_add_u32 s29, s29, 3072
  s_waitcnt vmcnt(5)
  buffer_load_dwordx4 v[68:71], v2, s[8:11], s29 offen
  s_add_u32 s29, s29, 3072
  s_waitcnt vmcnt(5)
  buffer_load_dwordx4 v[72:75], v2, s[8:11], s29 offen
  s_add_u32 s29, s29, 3072
  s_waitcnt vmcnt(5)
  buffer_load_dwordx4 v[76:79], v2, s[8:11], s29 offen
  s_add_u32 s29, s29, 3072
  s_waitcnt vmcnt(5)
  buffer_load_dwordx4 v[80:83], v2, s[8:11], s29 offen
  s_add_u32 s29, s29, 3072
  s_waitcnt vmcnt(5)
  buffer_load_dwordx4 v[84:87], v2, s[8:11], s29 offen
  ds_read_b32 v166, v165 offset:100
  s_waitcnt lgkmcnt(0)
  v_readfirstlane_b32 s42, v166
  s_xor_b32 s42, s42, 0x01010101
  s_cbranch_scc1 tb_main_40
  ds_read_b32 v166, v165 offset:116
  s_waitcnt lgkmcnt(0)
  v_readfirstlane_b32 s42, v166
  s_cmp_lg_u32 s42, 0
  s_cbranch_scc1 tb_main_40
  s_waitcnt vmcnt(5)
  buffer_load_dwordx4 v[88:91], v2, s[8:11], s26 offen offset:0
  s_waitcnt vmcnt(5)
  buffer_load_dwordx4 v[92:95], v2, s[8:11], s26 offen offset:1024
  s_waitcnt vmcnt(5)
  buffer_load_dwordx4 v[96:99], v2, s[8:11], s26 offen offset:2048
  s_add_u32 s26, s26, 3072
  s_waitcnt vmcnt(5)
  buffer_load_dwordx4 v[100:103], v2, s[8:11], s26 offen offset:0
  s_waitcnt vmcnt(5)
  buffer_load_dwordx4 v[104:107], v2, s[8:11], s26 offen offset:1024
  s_waitcnt vmcnt(5)
  buffer_load_dwordx4 v[108:111], v2, s[8:11], s26 offen offset:2048
  s_add_u32 s26, s26, 3072
  s_waitcnt vmcnt(5)
  buffer_load_dwordx4 v[112:115], v2, s[8:11], s26 offen offset:0
  s_waitcnt vmcnt(5)
  buffer_load_dwordx4 v[116:119], v2, s[8:11], s26 offen offset:1024
  s_waitcnt vmcnt(5)
  buffer_load_dwordx4 v[120:123], v2, s[8:11], s26 offen offset:2048
  s_add_u32 s26, s26, 3072
  s_waitcnt vmcnt(5)
  buffer_load_dwordx4 v[124:127], v2, s[8:11], s26 offen offset:0
  s_waitcnt vmcnt(5)
  buffer_load_dwordx4 v[128:131], v2, s[8:11], s26 offen offset:1024
  s_waitcnt vmcnt(5)
  buffer_load_dwordx4 v[132:135], v2, s[8:11], s26 offen offset:2048
  s_add_u32 s26, s26, 3072
  s_branch tb_main_40
ta_main_39:
  s_cmp_eq_u32 s3, 8
  s_cbranch_scc1 tb_main_40
  buffer_load_dwordx4 v[16:19], v2, s[8:11], s29 offen
  s_add_u32 s29, s29, 3072
  buffer_load_dwordx4 v[20:23], v2, s[8:11], s29 offen
  s_add_u32 s29, s29, 3072
  buffer_load_dwordx4 v[24:27], v2, s[8:11], s29 offen
  s_add_u32 s29, s29, 3072
  buffer_load_dwordx4 v[28:31], v2, s[8:11], s29 offen
  s_add_u32 s29, s29, 3072
  buffer_load_dwordx4 v[32:35], v2, s[8:11], s29 offen
  s_add_u32 s29, s29, 3072
  buffer_load_dwordx4 v[36:39], v2, s[8:11], s29 offen
  s_add_u32 s29, s29, 3072
  buffer_load_dwordx4 v[40:43], v2, s[8:11], s29 offen
  s_add_u32 s29, s29, 3072
  buffer_load_dwordx4 v[44:47], v2, s[8:11], s29 offen
  s_add_u32 s29, s29, 3072
  buffer_load_dwordx4 v[48:51], v2, s[8:11], s29 offen
  s_add_u32 s29, s29, 3072
  buffer_load_dwordx4 v[52:55], v2, s[8:11], s29 offen
  s_add_u32 s29, s29, 3072
  buffer_load_dwordx4 v[56:59], v2, s[8:11], s29 offen
  s_add_u32 s29, s29, 3072
  buffer_load_dwordx4 v[60:63], v2, s[8:11], s29 offen
  s_add_u32 s29, s29, 3072
  buffer_load_dwordx4 v[64:67], v2, s[8:11], s29 offen
  s_add_u32 s29, s29, 3072
  buffer_load_dwordx4 v[68:71], v2, s[8:11], s29 offen
  s_add_u32 s29, s29, 3072
  buffer_load_dwordx4 v[72:75], v2, s[8:11], s29 offen
  s_add_u32 s29, s29, 3072
  buffer_load_dwordx4 v[76:79], v2, s[8:11], s29 offen
  s_add_u32 s29, s29, 3072
  buffer_load_dwordx4 v[80:83], v2, s[8:11], s29 offen
  s_add_u32 s29, s29, 3072
  buffer_load_dwordx4 v[84:87], v2, s[8:11], s29 offen
tb_main_40:
  s_mov_b32 s44, s6
  s_mov_b32 s45, s7
  s_mov_b32 s46, 0x240000
  s_mov_b32 s47, 0x20000
  v_and_b32 v5, 15, v0
  v_bfe_u32 v6, v0, 4, 2
  s_lshl_b32 s33, s24, 5
  v_add_u32 v164, s33, v5
  v_mul_u32_u24 v164, 1152, v164
  s_lshl_b32 s33, s25, 5
  v_lshl_add_u32 v164, v6, 3, v164
  v_add_u32 v164, s33, v164
  v_lshlrev_b32 v4, 4, v6
  s_lshl_b32 s34, s25, 6
  s_add_u32 s35, s34, 9216
  s_add_u32 s36, s34, 11520
  s_add_u32 s34, s34, 4608
  s_mov_b32 s33, 18432
  buffer_load_dwordx2 v[160:161], v164, s[44:47], 0 offen
  buffer_load_dwordx2 v[162:163], v164, s[44:47], s33 offen
  buffer_load_dwordx4 v[152:155], v4, s[8:11], s34 offen
  buffer_load_dwordx4 v[156:159], v4, s[8:11], s35 offen
  s_cmp_eq_u32 s3, 8
  s_cbranch_scc1 og_main_37
  s_cmp_eq_u32 s22, 1
  s_cbranch_scc1 o5_main_45
  s_mul_i32 s41, s23, 5
  s_min_u32 s41, s41, 13
  s_and_b32 s33, s20, 3
  s_mul_i32 s33, s33, 165888
  s_mul_i32 s34, s41, 3072
  s_add_u32 s33, s33, s34
  s_add_u32 s33, s33, 14684160
  buffer_load_dwordx4 v[136:139], v2, s[8:11], s33 offen offset:0
  buffer_load_dwordx4 v[140:143], v2, s[8:11], s33 offen offset:3072
  s_add_u32 s33, s33, 6144
  buffer_load_dwordx4 v[144:147], v2, s[8:11], s33 offen offset:0
  buffer_load_dwordx4 v[148:151], v2, s[8:11], s33 offen offset:3072
  s_add_u32 s33, s33, 6144
  buffer_load_dwordx4 v[12:15], v2, s[8:11], s33 offen offset:0
  v_mov_b32 v8, -1
  v_mov_b32 v9, -1
  v_mov_b32 v10, -1
  v_mov_b32 v11, -1
  s_mul_i32 s32, s23, 9
  s_mul_i32 s33, s21, 72
  s_add_u32 s32, s32, s33
  s_lshl3_add_u32 s32, s32, s20
  s_lshl_b32 s32, s32, 10
  s_add_u32 s32, s32, 29147136
  s_add_u32 s33, s32, 0
  buffer_store_dwordx4 v[8:11], v2, s[8:11], s33 offen sc1
  s_add_u32 s33, s32, 294912
  buffer_store_dwordx4 v[8:11], v2, s[8:11], s33 offen sc1
  s_add_u32 s33, s32, 8192
  buffer_store_dwordx4 v[8:11], v2, s[8:11], s33 offen sc1
  s_add_u32 s33, s32, 303104
  buffer_store_dwordx4 v[8:11], v2, s[8:11], s33 offen sc1
  s_add_u32 s33, s32, 16384
  buffer_store_dwordx4 v[8:11], v2, s[8:11], s33 offen sc1
  s_add_u32 s33, s32, 311296
  buffer_store_dwordx4 v[8:11], v2, s[8:11], s33 offen sc1
  s_nop 4
  s_bfe_u32 s43, s2, 0x20004
  s_cmp_lg_u32 s43, 2
  s_cbranch_scc1 wt_main_46
  s_and_b32 s33, s20, 3
  s_mul_i32 s33, s33, 165888
  s_lshl_b32 s34, s23, 10
  s_add_u32 s33, s33, s34
  s_cmp_eq_u32 s23, 3
  s_cselect_b32 s34, 54272, 0
  s_add_u32 s33, s33, s34
  s_add_u32 s33, s33, 14628864
  s_mov_b32 s34, 3072
  v_lshrrev_b32 v8, 3, v1
  v_mul_u32_u24 v8, s34, v8
  v_and_b32 v9, 7, v1
  v_lshl_add_u32 v8, v9, 7, v8
  buffer_load_dword v9, v8, s[8:11], s33 offen
  s_mul_i32 s35, s34, 8
  s_add_u32 s33, s33, s35
  buffer_load_dword v9, v8, s[8:11], s33 offen
  s_mul_i32 s35, s34, 2
  s_add_u32 s33, s33, s35
  buffer_load_dword v9, v8, s[8:11], s33 offen
wt_main_46:
  s_cmp_lg_u32 s3, 0
  s_cbranch_scc1 wu_main_47
  s_mov_b32 s38, 0
  s_cmp_lt_u32 s2, 248
  s_cbranch_scc1 wq_main_52
  v_lshlrev_b32 v92, 5, v2
  s_mov_b32 s39, 57344
wm_main_50:
  buffer_load_dword v88, v92, s[8:11], s39 offen offset:0 sc1
  buffer_load_dword v89, v92, s[8:11], s39 offen offset:128 sc1
  buffer_load_dword v90, v92, s[8:11], s39 offen offset:256 sc1
  buffer_load_dword v91, v92, s[8:11], s39 offen offset:384 sc1
  s_add_u32 s38, s38, 1
  s_waitcnt vmcnt(0)
  v_and_b32 v88, v88, v89
  v_and_b32 v90, v90, v91
  v_and_b32 v88, v88, v90
  v_cmp_ne_u32 vcc, 1, v88
  s_nop 0
  s_cbranch_vccz wn_main_51
  s_sleep 2
  s_cmp_lt_u32 s38, 65536
  s_cbranch_scc1 wm_main_50
wn_main_51:
  v_lshlrev_b32 v92, 6, v2
  v_mov_b32 v88, 1
  s_lshl_b32 s39, s2, 7
  s_add_u32 s39, s39, 58368
  s_mov_b32 exec_hi, 0
  buffer_store_dword v88, v92, s[8:11], s39 offen sc1
wq_main_52:
  s_lshl_b32 s39, s2, 7
  s_add_u32 s39, s39, 90112
  s_mov_b64 exec, 1
wp_main_48:
  buffer_load_dword v88, v2, s[8:11], s39 offen sc1
  s_add_u32 s38, s38, 1
  s_waitcnt vmcnt(0)
  v_cmp_ne_u32 vcc, 1, v88
  s_nop 0
  s_cbranch_vccz wg_main_49
  s_sleep 4
  s_cmp_lt_u32 s38, 131072
  s_cbranch_scc1 wp_main_48
wg_main_49:
  s_mov_b64 exec, -1
  v_mov_b32 v88, 0x01010101
  ds_write_b32 v165, v88 offset:100
wu_main_47:
  ds_read_b32 v166, v165 offset:100
  s_waitcnt lgkmcnt(0)
  v_readfirstlane_b32 s32, v166
  s_cmp_lg_u32 s32, 0x1010101
  s_cbranch_scc1 cw_main_53
cr_main_54:
  ds_read_b32 v166, v165 offset:112
  s_waitcnt lgkmcnt(0)
  v_readfirstlane_b32 s42, v166
  s_cmp_lg_u32 s42, 0
  s_cbranch_scc1 wo_main_36
  buffer_load_dwordx4 v[88:91], v2, s[8:11], s26 offen offset:0
  buffer_load_dwordx4 v[92:95], v2, s[8:11], s26 offen offset:1024
  buffer_load_dwordx4 v[96:99], v2, s[8:11], s26 offen offset:2048
  s_add_u32 s26, s26, 3072
  buffer_load_dwordx4 v[100:103], v2, s[8:11], s26 offen offset:0
  buffer_load_dwordx4 v[104:107], v2, s[8:11], s26 offen offset:1024
  buffer_load_dwordx4 v[108:111], v2, s[8:11], s26 offen offset:2048
  s_add_u32 s26, s26, 3072
  buffer_load_dwordx4 v[112:115], v2, s[8:11], s26 offen offset:0
  buffer_load_dwordx4 v[116:119], v2, s[8:11], s26 offen offset:1024
  buffer_load_dwordx4 v[120:123], v2, s[8:11], s26 offen offset:2048
  s_add_u32 s26, s26, 3072
  buffer_load_dwordx4 v[124:127], v2, s[8:11], s26 offen offset:0
  buffer_load_dwordx4 v[128:131], v2, s[8:11], s26 offen offset:1024
  buffer_load_dwordx4 v[132:135], v2, s[8:11], s26 offen offset:2048
  s_add_u32 s26, s26, 3072
  s_cmp_gt_u32 s43, 1
  s_cbranch_scc1 wo_main_36
  s_lshl2_add_u32 s32, s43, s23
  s_mul_i32 s33, s20, 12
  s_add_u32 s33, s33, s32
  s_mul_i32 s33, s33, 58368
  s_add_u32 s33, s33, 15470592
  s_mov_b32 s34, 1024
  v_lshrrev_b32 v8, 3, v1
  v_mul_u32_u24 v8, s34, v8
  v_and_b32 v9, 7, v1
  v_lshl_add_u32 v8, v9, 7, v8
  buffer_load_dword v9, v8, s[8:11], s33 offen
  s_mul_i32 s35, s34, 8
  s_add_u32 s33, s33, s35
  buffer_load_dword v9, v8, s[8:11], s33 offen
  s_mul_i32 s35, s34, 2
  s_add_u32 s33, s33, s35
  buffer_load_dword v9, v8, s[8:11], s33 offen
wo_main_36:
  s_mul_i32 s34, s24, 36864
  s_mul_i32 s35, s22, 9216
  s_lshl_b32 s38, s23, 12
  s_add_u32 s35, s35, s38
  s_add_u32 s39, s34, s35
  s_add_u32 s39, s39, 12214272
  s_add_u32 s35, s35, 77824
  v_add_u32 v10, s35, v2
  s_mov_b32 s38, 0
  s_lshl_b32 s41, s41, 10
  v_add_u32 v11, s41, v2
  s_waitcnt vmcnt(0)
  v_mov_b32 v8, 1
  v_add_u32 v9, s3, v165
  ds_read_b32 v166, v165 offset:112
  s_waitcnt lgkmcnt(0)
  v_readfirstlane_b32 s32, v166
  s_cmp_lg_u32 s32, 0x1010101
  s_cbranch_scc1 cw_main_55
cr_main_56:
  ds_read_b32 v166, v165 offset:116
  s_waitcnt lgkmcnt(0)
  v_readfirstlane_b32 s32, v166
  s_cmp_lg_u32 s32, 0x1010101
  s_cbranch_scc1 cw_main_57
cr_main_58:
  ds_write_b128 v11, v[136:139] offset:0
  ds_write_b128 v11, v[140:143] offset:1024
  ds_write_b128 v11, v[144:147] offset:2048
  ds_write_b128 v11, v[148:151] offset:3072
  ds_write_b128 v11, v[12:15] offset:4096
  s_waitcnt lgkmcnt(0)
  ds_write_b8 v9, v8 offset:108
  s_sleep 6
o1_main_41:
  buffer_load_dwordx4 v[136:139], v2, s[8:11], s39 offen offset:0 sc1
  buffer_load_dwordx4 v[140:143], v2, s[8:11], s39 offen offset:1024 sc1
  buffer_load_dwordx4 v[144:147], v2, s[8:11], s39 offen offset:2048 sc1
  buffer_load_dwordx4 v[148:151], v2, s[8:11], s39 offen offset:3072 sc1
  s_waitcnt vmcnt(3)
  ds_write_b128 v10, v[136:139] offset:0
  v_max3_u32 v8, 0, v136, v137
  v_max3_u32 v8, v8, v138, v139
  s_waitcnt vmcnt(2)
  ds_write_b128 v10, v[140:143] offset:1024
  v_max3_u32 v8, v8, v140, v141
  v_max3_u32 v8, v8, v142, v143
  s_waitcnt vmcnt(1)
  ds_write_b128 v10, v[144:147] offset:2048
  v_max3_u32 v8, v8, v144, v145
  v_max3_u32 v8, v8, v146, v147
  s_waitcnt vmcnt(0)
  ds_write_b128 v10, v[148:151] offset:3072
  v_max3_u32 v8, v8, v148, v149
  v_max3_u32 v8, v8, v150, v151
  v_cmp_eq_u32 vcc, -1, v8
  s_waitcnt lgkmcnt(0)
  s_cbranch_vccz o2_main_42
  s_sleep 2
  s_add_u32 s38, s38, 1
  s_cmp_lt_u32 s38, 16384
  s_cbranch_scc1 o1_main_41
  s_branch o2_main_42
og_main_37:
  s_setprio 3
  s_mul_i32 s34, s24, 36864
  s_mul_i32 s35, s22, 9216
  s_lshl_b32 s38, s23, 12
  s_add_u32 s35, s35, s38
  s_add_u32 s39, s34, s35
  s_add_u32 s39, s39, 12214272
  s_add_u32 s35, s35, 77824
  v_add_u32 v10, s35, v2
  s_and_b32 s40, s23, 1
  s_lshr_b32 s35, s23, 1
  s_mul_i32 s38, s35, 18432
  s_add_u32 s34, s34, s38
  s_lshl_b32 s38, s40, 6
  s_add_u32 s34, s34, s38
  s_add_u32 s34, s34, 12230656
  v_and_b32 v9, 15, v1
  v_and_b32 v11, 48, v1
  v_lshlrev_b32 v11, 5, v11
  v_lshl_add_u32 v9, v9, 2, v11
  s_mul_i32 s40, s40, 18432
  s_lshl_b32 s35, s35, 10
  s_add_u32 s35, s35, s40
  s_add_u32 s35, s35, 94208
  v_add_u32 v11, s35, v2
  s_mov_b32 s38, 0
  ds_read_b32 v166, v165 offset:112
  s_waitcnt lgkmcnt(0)
  v_readfirstlane_b32 s32, v166
  s_cmp_lg_u32 s32, 0x1010101
  s_cbranch_scc1 cw_main_59
cr_main_60:
  ds_read_b32 v166, v165 offset:116
  s_waitcnt lgkmcnt(0)
  v_readfirstlane_b32 s32, v166
  s_cmp_lg_u32 s32, 0x1010101
  s_cbranch_scc1 cw_main_61
cr_main_62:
  s_sleep 6
o3_main_43:
  buffer_load_dwordx4 v[136:139], v2, s[8:11], s39 offen offset:0 sc1
  buffer_load_dwordx4 v[140:143], v2, s[8:11], s39 offen offset:1024 sc1
  buffer_load_dwordx4 v[144:147], v2, s[8:11], s39 offen offset:2048 sc1
  buffer_load_dwordx4 v[148:151], v2, s[8:11], s39 offen offset:3072 sc1
  buffer_load_dword v12, v9, s[8:11], s34 offen offset:0 sc1
  buffer_load_dword v13, v9, s[8:11], s34 offen offset:128 sc1
  buffer_load_dword v14, v9, s[8:11], s34 offen offset:256 sc1
  buffer_load_dword v15, v9, s[8:11], s34 offen offset:384 sc1
  s_add_u32 s38, s38, 1
  s_waitcnt vmcnt(7)
  v_max3_u32 v8, 0, v136, v137
  v_max3_u32 v8, v8, v138, v139
  s_waitcnt vmcnt(6)
  v_max3_u32 v8, v8, v140, v141
  v_max3_u32 v8, v8, v142, v143
  s_waitcnt vmcnt(5)
  v_max3_u32 v8, v8, v144, v145
  v_max3_u32 v8, v8, v146, v147
  s_waitcnt vmcnt(4)
  v_max3_u32 v8, v8, v148, v149
  v_max3_u32 v8, v8, v150, v151
  s_waitcnt vmcnt(0)
  v_max3_u32 v8, v8, v12, v13
  v_max3_u32 v8, v8, v14, v15
  v_cmp_eq_u32 vcc, -1, v8
  s_nop 0
  s_cbranch_vccz o4_main_44
  s_sleep 2
  s_cmp_lt_u32 s38, 16384
  s_cbranch_scc1 o3_main_43
o4_main_44:
  s_lshl_b32 s35, s23, 10
  v_add_u32 v40, s35, v2
  ds_read_b32 v166, v165 offset:108
  s_waitcnt lgkmcnt(0)
  v_readfirstlane_b32 s32, v166
  s_cmp_lg_u32 s32, 0x1010101
  s_cbranch_scc1 cw_main_64
cr_main_65:
  ds_read_b128 v[16:19], v40 offset:0
  ds_read_b128 v[20:23], v40 offset:4096
  ds_read_b128 v[24:27], v40 offset:8192
  ds_read_b128 v[28:31], v40 offset:12288
  ds_read_b128 v[32:35], v40 offset:16384
  v_add_u32 v41, 77824, v40
  s_add_u32 s35, s35, 36864
  v_add_u32 v42, s35, v41
  v_add_u32 v43, s3, v165
  v_mov_b32 v44, 1
o6_main_63:
  ds_write_b128 v10, v[136:139] offset:0
  ds_write_b128 v10, v[140:143] offset:1024
  ds_write_b128 v10, v[144:147] offset:2048
  ds_write_b128 v10, v[148:151] offset:3072
  ds_write_b128 v11, v[12:15]
o5_main_45:
  s_waitcnt vmcnt(0) lgkmcnt(0)
o2_main_42:
  s_setprio 2
  s_barrier
  s_cmp_lg_u32 s22, 2
  s_cbranch_scc1 k1_main_68
  s_setprio 3
  ds_read_b128 v[48:51], v41 offset:0
  ds_read_b128 v[52:55], v41 offset:18432
  ds_read_b128 v[56:59], v41 offset:4096
  ds_read_b128 v[60:63], v41 offset:22528
  ds_read_b128 v[64:67], v41 offset:8192
  ds_read_b128 v[68:71], v41 offset:26624
  ds_read_b128 v[72:75], v41 offset:12288
  ds_read_b128 v[76:79], v41 offset:30720
  ds_read_b128 v[80:83], v41 offset:16384
  ds_read_b128 v[84:87], v41 offset:34816
  s_waitcnt lgkmcnt(8)
  v_mfma_f32_16x16x32_bf16 v[8:11], v[16:19], v[48:51], 0
  v_mfma_f32_16x16x32_bf16 v[12:15], v[16:19], v[52:55], 0
  s_waitcnt lgkmcnt(6)
  v_mfma_f32_16x16x32_bf16 v[8:11], v[20:23], v[56:59], v[8:11]
  v_mfma_f32_16x16x32_bf16 v[12:15], v[20:23], v[60:63], v[12:15]
  s_waitcnt lgkmcnt(4)
  v_mfma_f32_16x16x32_bf16 v[8:11], v[24:27], v[64:67], v[8:11]
  v_mfma_f32_16x16x32_bf16 v[12:15], v[24:27], v[68:71], v[12:15]
  s_waitcnt lgkmcnt(2)
  v_mfma_f32_16x16x32_bf16 v[8:11], v[28:31], v[72:75], v[8:11]
  v_mfma_f32_16x16x32_bf16 v[12:15], v[28:31], v[76:79], v[12:15]
  s_waitcnt lgkmcnt(0)
  s_cmp_gt_u32 s23, 1
  s_cbranch_scc1 k2_main_69
  v_mfma_f32_16x16x32_bf16 v[8:11], v[32:35], v[80:83], v[8:11]
  v_mfma_f32_16x16x32_bf16 v[12:15], v[32:35], v[84:87], v[12:15]
k2_main_69:
  s_nop 7
  s_nop 7
  s_cmp_eq_u32 s3, 8
  s_cbranch_scc1 k3_main_70
  ds_write_b128 v42, v[8:11] offset:0
  ds_write_b128 v42, v[12:15] offset:1024
  s_waitcnt lgkmcnt(0)
  ds_write_b8 v43, v44 offset:116
  s_setprio 2
  s_branch ring_main_33
k3_main_70:
  ds_write_b8 v43, v44 offset:116
  ds_read_b32 v166, v165 offset:124
  s_waitcnt lgkmcnt(0)
  v_readfirstlane_b32 s32, v166
  s_cmp_lg_u32 s32, 0x1010101
  s_cbranch_scc1 cw_main_71
cr_main_72:
  ds_read_b128 v[48:51], v42 offset:2048
  ds_read_b128 v[52:55], v42 offset:3072
  ds_read_b128 v[56:59], v42 offset:4096
  ds_read_b128 v[60:63], v42 offset:5120
  ds_read_b128 v[64:67], v42 offset:6144
  ds_read_b128 v[68:71], v42 offset:7168
  s_waitcnt lgkmcnt(4)
  v_add_f32 v8, v8, v48
  v_add_f32 v9, v9, v49
  v_add_f32 v10, v10, v50
  v_add_f32 v11, v11, v51
  v_add_f32 v12, v12, v52
  v_add_f32 v13, v13, v53
  v_add_f32 v14, v14, v54
  v_add_f32 v15, v15, v55
  s_waitcnt lgkmcnt(2)
  v_add_f32 v8, v8, v56
  v_add_f32 v9, v9, v57
  v_add_f32 v10, v10, v58
  v_add_f32 v11, v11, v59
  v_add_f32 v12, v12, v60
  v_add_f32 v13, v13, v61
  v_add_f32 v14, v14, v62
  v_add_f32 v15, v15, v63
  s_waitcnt lgkmcnt(0)
  v_add_f32 v8, v8, v64
  v_add_f32 v9, v9, v65
  v_add_f32 v10, v10, v66
  v_add_f32 v11, v11, v67
  v_add_f32 v12, v12, v68
  v_add_f32 v13, v13, v69
  v_add_f32 v14, v14, v70
  v_add_f32 v15, v15, v71
  s_branch w2_main_67
k1_main_68:
  ds_read_b128 v[136:139], v7 offset:12288
  ds_read_b128 v[140:143], v7 offset:30720
  ds_read_b128 v[144:147], v7 offset:13312
  ds_read_b128 v[148:151], v7 offset:31744
  s_waitcnt lgkmcnt(2)
  v_mfma_f32_16x16x32_bf16 v[8:11], v[16:19], v[136:139], 0
  v_mfma_f32_16x16x32_bf16 v[12:15], v[16:19], v[140:143], 0
  ds_read_b128 v[136:139], v7 offset:14336
  ds_read_b128 v[140:143], v7 offset:32768
  s_waitcnt lgkmcnt(2)
  v_mfma_f32_16x16x32_bf16 v[8:11], v[20:23], v[144:147], v[8:11]
  v_mfma_f32_16x16x32_bf16 v[12:15], v[20:23], v[148:151], v[12:15]
  ds_read_b128 v[16:19], v7 offset:15360
  ds_read_b128 v[144:147], v7 offset:33792
  ds_read_b128 v[148:151], v7 offset:16384
  ds_read_b128 v[20:23], v7 offset:34816
  s_waitcnt lgkmcnt(4)
  v_mfma_f32_16x16x32_bf16 v[8:11], v[24:27], v[136:139], v[8:11]
  v_mfma_f32_16x16x32_bf16 v[12:15], v[24:27], v[140:143], v[12:15]
  ds_read_b128 v[136:139], v7 offset:17408
  ds_read_b128 v[140:143], v7 offset:35840
  s_waitcnt lgkmcnt(4)
  v_mfma_f32_16x16x32_bf16 v[8:11], v[28:31], v[16:19], v[8:11]
  v_mfma_f32_16x16x32_bf16 v[12:15], v[28:31], v[144:147], v[12:15]
  ds_read_b128 v[24:27], v7 offset:18432
  ds_read_b128 v[16:19], v7 offset:36864
  ds_read_b128 v[144:147], v7 offset:19456
  ds_read_b128 v[28:31], v7 offset:37888
  s_waitcnt lgkmcnt(6)
  v_mfma_f32_16x16x32_bf16 v[8:11], v[32:35], v[148:151], v[8:11]
  v_mfma_f32_16x16x32_bf16 v[12:15], v[32:35], v[20:23], v[12:15]
  ds_read_b128 v[148:151], v7 offset:20480
  ds_read_b128 v[20:23], v7 offset:38912
  s_waitcnt lgkmcnt(6)
  v_mfma_f32_16x16x32_bf16 v[8:11], v[36:39], v[136:139], v[8:11]
  v_mfma_f32_16x16x32_bf16 v[12:15], v[36:39], v[140:143], v[12:15]
  ds_read_b128 v[32:35], v7 offset:21504
  ds_read_b128 v[136:139], v7 offset:39936
  s_waitcnt lgkmcnt(6)
  v_mfma_f32_16x16x32_bf16 v[8:11], v[40:43], v[24:27], v[8:11]
  v_mfma_f32_16x16x32_bf16 v[12:15], v[40:43], v[16:19], v[12:15]
  ds_read_b128 v[140:143], v7 offset:22528
  ds_read_b128 v[36:39], v7 offset:40960
  s_waitcnt lgkmcnt(6)
  v_mfma_f32_16x16x32_bf16 v[8:11], v[44:47], v[144:147], v[8:11]
  v_mfma_f32_16x16x32_bf16 v[12:15], v[44:47], v[28:31], v[12:15]
  ds_read_b128 v[24:27], v7 offset:23552
  ds_read_b128 v[16:19], v7 offset:41984
  s_waitcnt lgkmcnt(6)
  v_mfma_f32_16x16x32_bf16 v[8:11], v[48:51], v[148:151], v[8:11]
  v_mfma_f32_16x16x32_bf16 v[12:15], v[48:51], v[20:23], v[12:15]
  ds_read_b128 v[40:43], v7 offset:24576
  ds_read_b128 v[144:147], v7 offset:43008
  s_waitcnt lgkmcnt(6)
  v_mfma_f32_16x16x32_bf16 v[8:11], v[52:55], v[32:35], v[8:11]
  v_mfma_f32_16x16x32_bf16 v[12:15], v[52:55], v[136:139], v[12:15]
  ds_read_b128 v[28:31], v7 offset:25600
  ds_read_b128 v[44:47], v7 offset:44032
  s_waitcnt lgkmcnt(6)
  v_mfma_f32_16x16x32_bf16 v[8:11], v[56:59], v[140:143], v[8:11]
  v_mfma_f32_16x16x32_bf16 v[12:15], v[56:59], v[36:39], v[12:15]
  ds_read_b128 v[148:151], v7 offset:26624
  ds_read_b128 v[20:23], v7 offset:45056
  s_waitcnt lgkmcnt(6)
  v_mfma_f32_16x16x32_bf16 v[8:11], v[60:63], v[24:27], v[8:11]
  v_mfma_f32_16x16x32_bf16 v[12:15], v[60:63], v[16:19], v[12:15]
  ds_read_b128 v[48:51], v7 offset:27648
  ds_read_b128 v[32:35], v7 offset:46080
  s_waitcnt lgkmcnt(6)
  v_mfma_f32_16x16x32_bf16 v[8:11], v[64:67], v[40:43], v[8:11]
  v_mfma_f32_16x16x32_bf16 v[12:15], v[64:67], v[144:147], v[12:15]
  ds_read_b128 v[136:139], v7 offset:28672
  ds_read_b128 v[52:55], v7 offset:47104
  s_waitcnt lgkmcnt(6)
  v_mfma_f32_16x16x32_bf16 v[8:11], v[68:71], v[28:31], v[8:11]
  v_mfma_f32_16x16x32_bf16 v[12:15], v[68:71], v[44:47], v[12:15]
  ds_read_b128 v[140:143], v7 offset:29696
  ds_read_b128 v[36:39], v7 offset:48128
  s_waitcnt lgkmcnt(6)
  v_mfma_f32_16x16x32_bf16 v[8:11], v[72:75], v[148:151], v[8:11]
  v_mfma_f32_16x16x32_bf16 v[12:15], v[72:75], v[20:23], v[12:15]
  s_waitcnt lgkmcnt(4)
  v_mfma_f32_16x16x32_bf16 v[8:11], v[76:79], v[48:51], v[8:11]
  v_mfma_f32_16x16x32_bf16 v[12:15], v[76:79], v[32:35], v[12:15]
  s_waitcnt lgkmcnt(2)
  v_mfma_f32_16x16x32_bf16 v[8:11], v[80:83], v[136:139], v[8:11]
  v_mfma_f32_16x16x32_bf16 v[12:15], v[80:83], v[52:55], v[12:15]
  s_waitcnt lgkmcnt(0)
  v_mfma_f32_16x16x32_bf16 v[8:11], v[84:87], v[140:143], v[8:11]
  v_mfma_f32_16x16x32_bf16 v[12:15], v[84:87], v[36:39], v[12:15]
w2_main_67:
  v_lshlrev_b32 v28, 16, v160
  v_and_b32 v29, 0xffff0000, v160
  v_lshlrev_b32 v30, 16, v161
  v_and_b32 v31, 0xffff0000, v161
  v_lshlrev_b32 v32, 16, v162
  v_and_b32 v33, 0xffff0000, v162
  v_lshlrev_b32 v34, 16, v163
  v_and_b32 v35, 0xffff0000, v163
  s_mul_i32 s37, s24, 36
  s_add_u32 s37, s37, s25
  s_lshl_b32 s38, s37, 10
  s_add_u32 s38, s38, 26148864
  v_fmac_f32 v28, v152, v8
  v_fmac_f32 v29, v153, v9
  v_fmac_f32 v30, v154, v10
  v_fmac_f32 v31, v155, v11
  v_fmac_f32 v32, v152, v12
  v_fmac_f32 v33, v153, v13
  v_fmac_f32 v34, v154, v14
  v_fmac_f32 v35, v155, v15
  v_cvt_pk_bf16_f32 v160, v28, v29
  v_cvt_pk_bf16_f32 v161, v30, v31
  v_cvt_pk_bf16_f32 v162, v32, v33
  v_cvt_pk_bf16_f32 v163, v34, v35
  v_lshlrev_b32 v28, 16, v160
  v_and_b32 v29, 0xffff0000, v160
  v_lshlrev_b32 v30, 16, v161
  v_and_b32 v31, 0xffff0000, v161
  v_lshlrev_b32 v32, 16, v162
  v_and_b32 v33, 0xffff0000, v162
  v_lshlrev_b32 v34, 16, v163
  v_and_b32 v35, 0xffff0000, v163
  v_mul_f32 v8, v156, v28
  v_mul_f32 v9, v157, v29
  v_mul_f32 v10, v158, v30
  v_mul_f32 v11, v159, v31
  v_mul_f32 v12, v156, v32
  v_mul_f32 v13, v157, v33
  v_mul_f32 v14, v158, v34
  v_mul_f32 v15, v159, v35
  v_cvt_pk_bf16_f32 v8, v8, v9
  v_cvt_pk_bf16_f32 v9, v10, v11
  v_cvt_pk_bf16_f32 v10, v12, v13
  v_cvt_pk_bf16_f32 v11, v14, v15
  buffer_store_dwordx4 v[8:11], v2, s[8:11], s38 offen sc1
  v_add_f32 v36, v28, v29
  v_add_f32 v38, v30, v31
  v_add_f32 v37, v32, v33
  v_add_f32 v39, v34, v35
  v_add_f32 v36, v36, v38
  v_add_f32 v37, v37, v39
  v_mov_b32 v38, v36
  v_mov_b32 v39, v37
  s_nop 0
  v_permlane16_swap_b32 v36, v38
  v_permlane16_swap_b32 v37, v39
  v_add_f32 v36, v36, v38
  v_add_f32 v37, v37, v39
  v_mov_b32 v38, v36
  v_mov_b32 v39, v37
  s_nop 0
  v_permlane32_swap_b32 v36, v38
  v_permlane32_swap_b32 v37, v39
  v_add_f32 v36, v36, v38
  v_add_f32 v37, v37, v39
  v_mov_b32 v44, 0xbd800000
  v_fmac_f32 v28, v44, v36
  v_fmac_f32 v29, v44, v36
  v_fmac_f32 v30, v44, v36
  v_fmac_f32 v31, v44, v36
  v_fmac_f32 v32, v44, v37
  v_fmac_f32 v33, v44, v37
  v_fmac_f32 v34, v44, v37
  v_fmac_f32 v35, v44, v37
  v_mul_f32 v40, v28, v28
  v_mul_f32 v41, v32, v32
  v_fmac_f32 v40, v29, v29
  v_fmac_f32 v41, v33, v33
  v_fmac_f32 v40, v30, v30
  v_fmac_f32 v41, v34, v34
  v_fmac_f32 v40, v31, v31
  v_fmac_f32 v41, v35, v35
  v_mov_b32 v42, v40
  v_mov_b32 v43, v41
  s_nop 0
  v_permlane16_swap_b32 v40, v42
  v_permlane16_swap_b32 v41, v43
  v_add_f32 v40, v40, v42
  v_add_f32 v41, v41, v43
  v_mov_b32 v42, v40
  v_mov_b32 v43, v41
  s_nop 0
  v_permlane32_swap_b32 v40, v42
  v_permlane32_swap_b32 v41, v43
  v_add_f32 v40, v40, v42
  v_add_f32 v41, v41, v43
  v_cmp_gt_u32 vcc, 16, v1
  s_nop 1
  v_cndmask_b32 v44, v37, v36, vcc
  v_cndmask_b32 v45, v41, v40, vcc
  v_mul_u32_u24 v6, 4608, v6
  v_lshl_add_u32 v6, v5, 3, v6
  s_mul_i32 s38, s24, 9216
  s_lshl_b32 s39, s25, 7
  s_add_u32 s38, s38, s39
  s_add_u32 s38, s38, 28508160
  s_mov_b32 exec_hi, 0
  buffer_store_dwordx2 v[44:45], v6, s[8:11], s38 offen sc1
  s_mov_b32 exec_hi, -1
  v_mov_b32 v4, 0x01010101
  ds_write_b32 v165, v4 offset:120
ring_main_33:
  v_add_u32 v6, s3, v165
  s_cmp_eq_u32 s22, 2
  s_cbranch_scc1 gath_main_34
  s_setprio 1
  s_cmp_eq_u32 s42, 0
  s_cbranch_scc1 r3_main_73
  s_cmp_eq_u32 s22, 0
  s_cbranch_scc1 r4_main_74
  ds_read_b32 v166, v165 offset:16
  s_waitcnt lgkmcnt(0)
  v_readfirstlane_b32 s32, v166
  s_cmp_lg_u32 s32, 0x1010101
  s_cbranch_scc1 cw_main_75
cr_main_76:
r4_main_74:
  buffer_load_dwordx4 v[88:91], v2, s[8:11], s26 offen offset:0
  buffer_load_dwordx4 v[92:95], v2, s[8:11], s26 offen offset:1024
  buffer_load_dwordx4 v[96:99], v2, s[8:11], s26 offen offset:2048
  s_add_u32 s26, s26, 3072
  buffer_load_dwordx4 v[100:103], v2, s[8:11], s26 offen offset:0
  buffer_load_dwordx4 v[104:107], v2, s[8:11], s26 offen offset:1024
  buffer_load_dwordx4 v[108:111], v2, s[8:11], s26 offen offset:2048
  s_add_u32 s26, s26, 3072
  buffer_load_dwordx4 v[112:115], v2, s[8:11], s26 offen offset:0
  buffer_load_dwordx4 v[116:119], v2, s[8:11], s26 offen offset:1024
  buffer_load_dwordx4 v[120:123], v2, s[8:11], s26 offen offset:2048
  s_add_u32 s26, s26, 3072
  buffer_load_dwordx4 v[124:127], v2, s[8:11], s26 offen offset:0
  buffer_load_dwordx4 v[128:131], v2, s[8:11], s26 offen offset:1024
  buffer_load_dwordx4 v[132:135], v2, s[8:11], s26 offen offset:2048
  s_add_u32 s26, s26, 3072
r3_main_73:
  buffer_load_dwordx4 v[136:139], v2, s[8:11], s26 offen offset:0
  buffer_load_dwordx4 v[140:143], v2, s[8:11], s26 offen offset:1024
  buffer_load_dwordx4 v[144:147], v2, s[8:11], s26 offen offset:2048
  s_add_u32 s26, s26, 3072
  buffer_load_dwordx4 v[148:151], v2, s[8:11], s26 offen offset:0
  buffer_load_dwordx4 v[152:155], v2, s[8:11], s26 offen offset:1024
  buffer_load_dwordx4 v[156:159], v2, s[8:11], s26 offen offset:2048
  s_add_u32 s26, s26, 3072
  s_branch main_main_35
gath_main_34:
  buffer_load_dwordx4 v[88:91], v2, s[8:11], s26 offen offset:0
  buffer_load_dwordx4 v[92:95], v2, s[8:11], s26 offen offset:1024
  buffer_load_dwordx4 v[96:99], v2, s[8:11], s26 offen offset:2048
  s_add_u32 s26, s26, 3072
  buffer_load_dwordx4 v[100:103], v2, s[8:11], s26 offen offset:0
  buffer_load_dwordx4 v[104:107], v2, s[8:11], s26 offen offset:1024
  buffer_load_dwordx4 v[108:111], v2, s[8:11], s26 offen offset:2048
  s_add_u32 s26, s26, 3072
  buffer_load_dwordx4 v[112:115], v2, s[8:11], s26 offen offset:0
  buffer_load_dwordx4 v[116:119], v2, s[8:11], s26 offen offset:1024
  buffer_load_dwordx4 v[120:123], v2, s[8:11], s26 offen offset:2048
  s_add_u32 s26, s26, 3072
  s_setprio 3
  ds_read_b32 v166, v165 offset:120
  s_waitcnt lgkmcnt(0)
  v_readfirstlane_b32 s32, v166
  s_cmp_lg_u32 s32, 0x1010101
  s_cbranch_scc1 cw_main_77
cr_main_78:
  s_and_b32 s32, s23, 1
  s_lshl1_add_u32 s33, s21, s32
  s_mul_i32 s33, s33, 36864
  s_lshr_b32 s34, s23, 1
  s_lshl_b32 s35, s34, 11
  s_add_u32 s33, s33, s35
  s_add_u32 s33, s33, 26148864
  s_lshl_b32 s34, s34, 12
  s_lshl_b32 s32, s32, 11
  s_add_u32 s34, s34, s32
  v_add_u32 v5, s34, v2
  v_add_u32 v11, 0x8000, v5
  s_lshl2_add_u32 s35, s21, s23
  s_mul_i32 s35, s35, 4608
  s_add_u32 s35, s35, 28508160
  v_lshlrev_b32 v4, 3, v1
  v_min_u32 v9, 17, v1
  v_and_b32 v10, 30, v9
  v_add_u32 v9, v9, v10
  v_lshlrev_b32 v9, 10, v9
  v_mov_b32 v10, 1
  s_mov_b32 s38, 0
  s_sleep 16
yp_main_79:
  buffer_load_dword v8, v9, s[8:11], s33 offen offset:1020 sc1
  s_add_u32 s39, s33, 0
  buffer_load_dwordx4 v[16:19], v2, s[8:11], s39 offen sc1
  buffer_load_dwordx4 v[20:23], v2, s[8:11], s39 offen offset:1024 sc1
  s_add_u32 s39, s33, 4096
  buffer_load_dwordx4 v[24:27], v2, s[8:11], s39 offen sc1
  buffer_load_dwordx4 v[28:31], v2, s[8:11], s39 offen offset:1024 sc1
  s_add_u32 s39, s33, 8192
  buffer_load_dwordx4 v[32:35], v2, s[8:11], s39 offen sc1
  buffer_load_dwordx4 v[36:39], v2, s[8:11], s39 offen offset:1024 sc1
  s_add_u32 s38, s38, 1
  s_waitcnt vmcnt(6)
  v_cmp_eq_u32 vcc, -1, v8
  s_nop 0
  s_cbranch_vccz yg_main_80
  s_waitcnt vmcnt(0)
  s_sleep 1
  s_cmp_lt_u32 s38, 16384
  s_cbranch_scc1 yp_main_79
yg_main_80:
  s_add_u32 s39, s33, 12288
  buffer_load_dwordx4 v[40:43], v2, s[8:11], s39 offen
  buffer_load_dwordx4 v[44:47], v2, s[8:11], s39 offen offset:1024
  s_add_u32 s39, s33, 16384
  buffer_load_dwordx4 v[48:51], v2, s[8:11], s39 offen
  buffer_load_dwordx4 v[52:55], v2, s[8:11], s39 offen offset:1024
  s_waitcnt vmcnt(8)
  s_add_u32 s39, s33, 20480
  buffer_load_dwordx4 v[56:59], v2, s[8:11], s39 offen
  buffer_load_dwordx4 v[60:63], v2, s[8:11], s39 offen offset:1024
  v_swap_b32 v18, v20
  v_swap_b32 v19, v21
  ds_write_b128 v5, v[16:19] offset:0
  ds_write_b128 v5, v[20:23] offset:1024
  v_max3_u32 v8, 0, v16, v17
  v_max3_u32 v8, v8, v18, v19
  v_max3_u32 v8, v8, v20, v21
  v_max3_u32 v8, v8, v22, v23
  s_waitcnt vmcnt(8)
  s_add_u32 s39, s33, 24576
  buffer_load_dwordx4 v[64:67], v2, s[8:11], s39 offen
  buffer_load_dwordx4 v[68:71], v2, s[8:11], s39 offen offset:1024
  v_swap_b32 v26, v28
  v_swap_b32 v27, v29
  ds_write_b128 v5, v[24:27] offset:8192
  ds_write_b128 v5, v[28:31] offset:9216
  v_max3_u32 v8, v8, v24, v25
  v_max3_u32 v8, v8, v26, v27
  v_max3_u32 v8, v8, v28, v29
  v_max3_u32 v8, v8, v30, v31
  s_waitcnt vmcnt(8)
  s_add_u32 s39, s33, 28672
  buffer_load_dwordx4 v[72:75], v2, s[8:11], s39 offen
  buffer_load_dwordx4 v[76:79], v2, s[8:11], s39 offen offset:1024
  v_swap_b32 v34, v36
  v_swap_b32 v35, v37
  ds_write_b128 v5, v[32:35] offset:16384
  ds_write_b128 v5, v[36:39] offset:17408
  v_max3_u32 v8, v8, v32, v33
  v_max3_u32 v8, v8, v34, v35
  v_max3_u32 v8, v8, v36, v37
  v_max3_u32 v8, v8, v38, v39
  v_cmp_eq_u32 vcc, -1, v8
  s_nop 0
  s_cbranch_vccnz gs_main_81
gr_main_82:
  s_waitcnt lgkmcnt(0)
  ds_write_b8 v6, v10 offset:8
  s_waitcnt vmcnt(8)
  s_add_u32 s39, s33, 32768
  buffer_load_dwordx4 v[80:83], v2, s[8:11], s39 offen
  buffer_load_dwordx4 v[84:87], v2, s[8:11], s39 offen offset:1024
  v_swap_b32 v42, v44
  v_swap_b32 v43, v45
  ds_write_b128 v5, v[40:43] offset:24576
  ds_write_b128 v5, v[44:47] offset:25600
  v_max3_u32 v8, 0, v40, v41
  v_max3_u32 v8, v8, v42, v43
  v_max3_u32 v8, v8, v44, v45
  v_max3_u32 v8, v8, v46, v47
  s_waitcnt vmcnt(8)
  buffer_load_dwordx2 v[16:17], v4, s[8:11], s35 offen offset:0
  buffer_load_dwordx2 v[18:19], v4, s[8:11], s35 offen offset:512
  v_swap_b32 v50, v52
  v_swap_b32 v51, v53
  ds_write_b128 v11, v[48:51] offset:0
  ds_write_b128 v11, v[52:55] offset:1024
  v_max3_u32 v8, v8, v48, v49
  v_max3_u32 v8, v8, v50, v51
  v_max3_u32 v8, v8, v52, v53
  v_max3_u32 v8, v8, v54, v55
  s_waitcnt vmcnt(8)
  buffer_load_dwordx2 v[20:21], v4, s[8:11], s35 offen offset:1024
  buffer_load_dwordx2 v[22:23], v4, s[8:11], s35 offen offset:1536
  v_swap_b32 v58, v60
  v_swap_b32 v59, v61
  ds_write_b128 v11, v[56:59] offset:8192
  ds_write_b128 v11, v[60:63] offset:9216
  v_max3_u32 v8, v8, v56, v57
  v_max3_u32 v8, v8, v58, v59
  v_max3_u32 v8, v8, v60, v61
  v_max3_u32 v8, v8, v62, v63
  v_cmp_eq_u32 vcc, -1, v8
  s_nop 0
  s_cbranch_vccnz gs_main_83
gr_main_84:
  s_waitcnt lgkmcnt(0)
  ds_write_b8 v6, v10 offset:12
  s_waitcnt vmcnt(8)
  buffer_load_dwordx2 v[24:25], v4, s[8:11], s35 offen offset:2048
  buffer_load_dwordx2 v[26:27], v4, s[8:11], s35 offen offset:2560
  v_swap_b32 v66, v68
  v_swap_b32 v67, v69
  ds_write_b128 v11, v[64:67] offset:16384
  ds_write_b128 v11, v[68:71] offset:17408
  v_max3_u32 v8, 0, v64, v65
  v_max3_u32 v8, v8, v66, v67
  v_max3_u32 v8, v8, v68, v69
  v_max3_u32 v8, v8, v70, v71
  s_waitcnt vmcnt(8)
  buffer_load_dwordx2 v[28:29], v4, s[8:11], s35 offen offset:3072
  buffer_load_dwordx2 v[30:31], v4, s[8:11], s35 offen offset:3584
  v_swap_b32 v74, v76
  v_swap_b32 v75, v77
  ds_write_b128 v11, v[72:75] offset:24576
  ds_write_b128 v11, v[76:79] offset:25600
  v_max3_u32 v8, v8, v72, v73
  v_max3_u32 v8, v8, v74, v75
  v_max3_u32 v8, v8, v76, v77
  v_max3_u32 v8, v8, v78, v79
  s_waitcnt vmcnt(8)
  s_add_u32 s39, s35, 4096
  buffer_load_dwordx2 v[32:33], v4, s[8:11], s39 offen
  v_swap_b32 v82, v84
  v_swap_b32 v83, v85
  ds_write_b128 v11, v[80:83] offset:32768
  ds_write_b128 v11, v[84:87] offset:33792
  v_max3_u32 v8, v8, v80, v81
  v_max3_u32 v8, v8, v82, v83
  v_max3_u32 v8, v8, v84, v85
  v_max3_u32 v8, v8, v86, v87
  v_cmp_eq_u32 vcc, -1, v8
  s_nop 0
  s_cbranch_vccnz gs_main_85
gr_main_86:
  s_waitcnt lgkmcnt(0)
  ds_write_b8 v6, v10 offset:16
s1_main_87:
  s_waitcnt vmcnt(0)
  v_max3_u32 v8, v16, v17, v18
  v_max3_u32 v8, v8, v19, v20
  v_max3_u32 v8, v8, v21, v22
  v_max3_u32 v8, v8, v23, v24
  v_max3_u32 v8, v8, v25, v26
  v_max3_u32 v8, v8, v27, v28
  v_max3_u32 v8, v8, v29, v30
  v_max3_u32 v8, v8, v31, v32
  v_max_u32 v8, v8, v33
  v_cmp_eq_u32 vcc, -1, v8
  s_nop 0
  s_cbranch_vccz s2_main_88
  buffer_load_dwordx2 v[16:17], v4, s[8:11], s35 offen offset:0 sc1
  buffer_load_dwordx2 v[18:19], v4, s[8:11], s35 offen offset:512 sc1
  buffer_load_dwordx2 v[20:21], v4, s[8:11], s35 offen offset:1024 sc1
  buffer_load_dwordx2 v[22:23], v4, s[8:11], s35 offen offset:1536 sc1
  buffer_load_dwordx2 v[24:25], v4, s[8:11], s35 offen offset:2048 sc1
  buffer_load_dwordx2 v[26:27], v4, s[8:11], s35 offen offset:2560 sc1
  buffer_load_dwordx2 v[28:29], v4, s[8:11], s35 offen offset:3072 sc1
  buffer_load_dwordx2 v[30:31], v4, s[8:11], s35 offen offset:3584 sc1
  buffer_load_dwordx2 v[32:33], v4, s[8:11], s39 offen sc1
  s_add_u32 s38, s38, 1
  s_cmp_lt_u32 s38, 16384
  s_cbranch_scc1 s1_main_87
  s_waitcnt vmcnt(0)
s2_main_88:
  v_add_f32 v8, v16, v18
  v_add_f32 v10, v17, v19
  v_add_f32 v8, v8, v20
  v_add_f32 v10, v10, v21
  v_add_f32 v8, v8, v22
  v_add_f32 v10, v10, v23
  v_add_f32 v8, v8, v24
  v_add_f32 v10, v10, v25
  v_add_f32 v8, v8, v26
  v_add_f32 v10, v10, v27
  v_add_f32 v8, v8, v28
  v_add_f32 v10, v10, v29
  v_add_f32 v8, v8, v30
  v_add_f32 v10, v10, v31
  v_add_f32 v8, v8, v32
  v_add_f32 v10, v10, v33
  v_mov_b32 v9, v8
  s_nop 1
  v_permlane16_swap_b32 v8, v9
  v_add_f32 v8, v8, v9
  v_mov_b32 v9, v8
  s_nop 1
  v_permlane32_swap_b32 v8, v9
  v_add_f32 v8, v8, v9
  v_mul_f32 v8, 0x3ae38e39, v8
  v_mov_b32 v11, 0x3e800000
  v_mul_f32 v9, 4.0, v8
  v_fma_f32 v16, v16, v11, -v9
  v_fma_f32 v18, v18, v11, -v9
  v_fma_f32 v20, v20, v11, -v9
  v_fma_f32 v22, v22, v11, -v9
  v_fma_f32 v24, v24, v11, -v9
  v_fma_f32 v26, v26, v11, -v9
  v_fma_f32 v28, v28, v11, -v9
  v_fma_f32 v30, v30, v11, -v9
  v_fma_f32 v32, v32, v11, -v9
  v_fmac_f32 v10, v16, v16
  v_fmac_f32 v10, v18, v18
  v_fmac_f32 v10, v20, v20
  v_fmac_f32 v10, v22, v22
  v_fmac_f32 v10, v24, v24
  v_fmac_f32 v10, v26, v26
  v_fmac_f32 v10, v28, v28
  v_fmac_f32 v10, v30, v30
  v_fmac_f32 v10, v32, v32
  v_mov_b32 v9, v10
  s_nop 1
  v_permlane16_swap_b32 v10, v9
  v_add_f32 v10, v10, v9
  v_mov_b32 v9, v10
  s_nop 1
  v_permlane32_swap_b32 v10, v9
  v_add_f32 v10, v10, v9
  v_mul_f32 v10, 0x3ae38e39, v10
  v_cvt_pk_bf16_f32 v10, v10, v10
  v_lshlrev_b32 v10, 16, v10
  v_add_f32 v10, 0x3727c5ac, v10
  v_cvt_pk_bf16_f32 v10, v10, v10
  v_lshlrev_b32 v10, 16, v10
  v_sqrt_f32 v10, v10
  s_lshl_b32 s32, s23, 10
  s_add_u32 s32, s32, 73728
  v_add_u32 v5, s32, v2
  v_cvt_pk_bf16_f32 v8, -v8, v10
  v_mov_b32 v9, v8
  v_mov_b32 v10, v8
  v_mov_b32 v11, v8
  ds_write_b128 v5, v[8:11]
  v_mov_b32 v4, 1
  s_waitcnt lgkmcnt(0)
  ds_write_b8 v6, v4 offset:4
  s_setprio 1
  buffer_load_dwordx4 v[124:127], v2, s[8:11], s26 offen offset:0
  buffer_load_dwordx4 v[128:131], v2, s[8:11], s26 offen offset:1024
  buffer_load_dwordx4 v[132:135], v2, s[8:11], s26 offen offset:2048
  s_add_u32 s26, s26, 3072
  buffer_load_dwordx4 v[136:139], v2, s[8:11], s26 offen offset:0
  buffer_load_dwordx4 v[140:143], v2, s[8:11], s26 offen offset:1024
  buffer_load_dwordx4 v[144:147], v2, s[8:11], s26 offen offset:2048
  s_add_u32 s26, s26, 3072
  buffer_load_dwordx4 v[148:151], v2, s[8:11], s26 offen offset:0
  buffer_load_dwordx4 v[152:155], v2, s[8:11], s26 offen offset:1024
  buffer_load_dwordx4 v[156:159], v2, s[8:11], s26 offen offset:2048
  s_add_u32 s26, s26, 3072
main_main_35:
  v_mov_b32 v4, 1
  ds_read_u8 v166, v6 offset:28
  s_waitcnt lgkmcnt(0)
  v_readfirstlane_b32 s32, v166
  s_cmp_lg_u32 s32, 0x1
  s_cbranch_scc1 cw_main_89
cr_main_90:
  ds_read_b32 v166, v165 offset:16
  s_waitcnt lgkmcnt(0)
  v_readfirstlane_b32 s32, v166
  s_cmp_lg_u32 s32, 0x1010101
  s_cbranch_scc1 cw_main_91
cr_main_92:
  ds_read_b128 v[56:59], v2 offset:0
  ds_read_b128 v[60:63], v2 offset:1024
  ds_read_b128 v[64:67], v2 offset:2048
  ds_read_b128 v[68:71], v2 offset:3072
  ds_read_b128 v[72:75], v2 offset:4096
  ds_read_b128 v[76:79], v2 offset:5120
  ds_read_b128 v[80:83], v2 offset:6144
  ds_read_b128 v[84:87], v2 offset:7168
  s_waitcnt vmcnt(15) lgkmcnt(4)
  v_mfma_f32_16x16x32_bf16 v[8:11], v[88:91], v[56:59], 0
  v_mfma_f32_16x16x32_bf16 v[12:15], v[88:91], v[60:63], 0
  v_mfma_f32_16x16x32_bf16 v[16:19], v[88:91], v[64:67], 0
  v_mfma_f32_16x16x32_bf16 v[20:23], v[88:91], v[68:71], 0
  buffer_load_dwordx4 v[88:91], v2, s[8:11], s26 offen offset:0
  v_mfma_f32_16x16x32_bf16 v[24:27], v[92:95], v[56:59], 0
  v_mfma_f32_16x16x32_bf16 v[28:31], v[92:95], v[60:63], 0
  v_mfma_f32_16x16x32_bf16 v[32:35], v[92:95], v[64:67], 0
  v_mfma_f32_16x16x32_bf16 v[36:39], v[92:95], v[68:71], 0
  buffer_load_dwordx4 v[92:95], v2, s[8:11], s26 offen offset:1024
  v_mfma_f32_16x16x32_bf16 v[40:43], v[96:99], v[56:59], 0
  v_mfma_f32_16x16x32_bf16 v[44:47], v[96:99], v[60:63], 0
  v_mfma_f32_16x16x32_bf16 v[48:51], v[96:99], v[64:67], 0
  v_mfma_f32_16x16x32_bf16 v[52:55], v[96:99], v[68:71], 0
  buffer_load_dwordx4 v[96:99], v2, s[8:11], s26 offen offset:2048
  s_add_u32 s26, s26, 3072
  ds_read_b128 v[56:59], v2 offset:8192
  ds_read_b128 v[60:63], v2 offset:9216
  ds_read_b128 v[64:67], v2 offset:10240
  ds_read_b128 v[68:71], v2 offset:11264
  s_waitcnt vmcnt(15) lgkmcnt(4)
  v_mfma_f32_16x16x32_bf16 v[8:11], v[100:103], v[72:75], v[8:11]
  v_mfma_f32_16x16x32_bf16 v[12:15], v[100:103], v[76:79], v[12:15]
  v_mfma_f32_16x16x32_bf16 v[16:19], v[100:103], v[80:83], v[16:19]
  v_mfma_f32_16x16x32_bf16 v[20:23], v[100:103], v[84:87], v[20:23]
  buffer_load_dwordx4 v[100:103], v2, s[8:11], s26 offen offset:0
  v_mfma_f32_16x16x32_bf16 v[24:27], v[104:107], v[72:75], v[24:27]
  v_mfma_f32_16x16x32_bf16 v[28:31], v[104:107], v[76:79], v[28:31]
  v_mfma_f32_16x16x32_bf16 v[32:35], v[104:107], v[80:83], v[32:35]
  v_mfma_f32_16x16x32_bf16 v[36:39], v[104:107], v[84:87], v[36:39]
  buffer_load_dwordx4 v[104:107], v2, s[8:11], s26 offen offset:1024
  v_mfma_f32_16x16x32_bf16 v[40:43], v[108:111], v[72:75], v[40:43]
  v_mfma_f32_16x16x32_bf16 v[44:47], v[108:111], v[76:79], v[44:47]
  v_mfma_f32_16x16x32_bf16 v[48:51], v[108:111], v[80:83], v[48:51]
  v_mfma_f32_16x16x32_bf16 v[52:55], v[108:111], v[84:87], v[52:55]
  buffer_load_dwordx4 v[108:111], v2, s[8:11], s26 offen offset:2048
  s_add_u32 s26, s26, 3072
  ds_read_b128 v[72:75], v2 offset:12288
  ds_read_b128 v[76:79], v2 offset:13312
  ds_read_b128 v[80:83], v2 offset:14336
  ds_read_b128 v[84:87], v2 offset:15360
  s_waitcnt vmcnt(15) lgkmcnt(4)
  v_mfma_f32_16x16x32_bf16 v[8:11], v[112:115], v[56:59], v[8:11]
  v_mfma_f32_16x16x32_bf16 v[12:15], v[112:115], v[60:63], v[12:15]
  v_mfma_f32_16x16x32_bf16 v[16:19], v[112:115], v[64:67], v[16:19]
  v_mfma_f32_16x16x32_bf16 v[20:23], v[112:115], v[68:71], v[20:23]
  buffer_load_dwordx4 v[112:115], v2, s[8:11], s26 offen offset:0
  v_mfma_f32_16x16x32_bf16 v[24:27], v[116:119], v[56:59], v[24:27]
  v_mfma_f32_16x16x32_bf16 v[28:31], v[116:119], v[60:63], v[28:31]
  v_mfma_f32_16x16x32_bf16 v[32:35], v[116:119], v[64:67], v[32:35]
  v_mfma_f32_16x16x32_bf16 v[36:39], v[116:119], v[68:71], v[36:39]
  buffer_load_dwordx4 v[116:119], v2, s[8:11], s26 offen offset:1024
  v_mfma_f32_16x16x32_bf16 v[40:43], v[120:123], v[56:59], v[40:43]
  v_mfma_f32_16x16x32_bf16 v[44:47], v[120:123], v[60:63], v[44:47]
  v_mfma_f32_16x16x32_bf16 v[48:51], v[120:123], v[64:67], v[48:51]
  v_mfma_f32_16x16x32_bf16 v[52:55], v[120:123], v[68:71], v[52:55]
  buffer_load_dwordx4 v[120:123], v2, s[8:11], s26 offen offset:2048
  s_add_u32 s26, s26, 3072
  ds_read_b128 v[56:59], v2 offset:16384
  ds_read_b128 v[60:63], v2 offset:17408
  ds_read_b128 v[64:67], v2 offset:18432
  ds_read_b128 v[68:71], v2 offset:19456
  s_waitcnt vmcnt(15) lgkmcnt(4)
  v_mfma_f32_16x16x32_bf16 v[8:11], v[124:127], v[72:75], v[8:11]
  v_mfma_f32_16x16x32_bf16 v[12:15], v[124:127], v[76:79], v[12:15]
  v_mfma_f32_16x16x32_bf16 v[16:19], v[124:127], v[80:83], v[16:19]
  v_mfma_f32_16x16x32_bf16 v[20:23], v[124:127], v[84:87], v[20:23]
  buffer_load_dwordx4 v[124:127], v2, s[8:11], s26 offen offset:0
  v_mfma_f32_16x16x32_bf16 v[24:27], v[128:131], v[72:75], v[24:27]
  v_mfma_f32_16x16x32_bf16 v[28:31], v[128:131], v[76:79], v[28:31]
  v_mfma_f32_16x16x32_bf16 v[32:35], v[128:131], v[80:83], v[32:35]
  v_mfma_f32_16x16x32_bf16 v[36:39], v[128:131], v[84:87], v[36:39]
  buffer_load_dwordx4 v[128:131], v2, s[8:11], s26 offen offset:1024
  v_mfma_f32_16x16x32_bf16 v[40:43], v[132:135], v[72:75], v[40:43]
  v_mfma_f32_16x16x32_bf16 v[44:47], v[132:135], v[76:79], v[44:47]
  v_mfma_f32_16x16x32_bf16 v[48:51], v[132:135], v[80:83], v[48:51]
  v_mfma_f32_16x16x32_bf16 v[52:55], v[132:135], v[84:87], v[52:55]
  buffer_load_dwordx4 v[132:135], v2, s[8:11], s26 offen offset:2048
  s_add_u32 s26, s26, 3072
  ds_read_b128 v[72:75], v2 offset:20480
  ds_read_b128 v[76:79], v2 offset:21504
  ds_read_b128 v[80:83], v2 offset:22528
  ds_read_b128 v[84:87], v2 offset:23552
  ds_read_b32 v166, v165 offset:20
  s_waitcnt vmcnt(15) lgkmcnt(5)
  v_mfma_f32_16x16x32_bf16 v[8:11], v[136:139], v[56:59], v[8:11]
  v_mfma_f32_16x16x32_bf16 v[12:15], v[136:139], v[60:63], v[12:15]
  v_mfma_f32_16x16x32_bf16 v[16:19], v[136:139], v[64:67], v[16:19]
  v_mfma_f32_16x16x32_bf16 v[20:23], v[136:139], v[68:71], v[20:23]
  buffer_load_dwordx4 v[136:139], v2, s[8:11], s26 offen offset:0
  v_mfma_f32_16x16x32_bf16 v[24:27], v[140:143], v[56:59], v[24:27]
  v_mfma_f32_16x16x32_bf16 v[28:31], v[140:143], v[60:63], v[28:31]
  v_mfma_f32_16x16x32_bf16 v[32:35], v[140:143], v[64:67], v[32:35]
  v_mfma_f32_16x16x32_bf16 v[36:39], v[140:143], v[68:71], v[36:39]
  buffer_load_dwordx4 v[140:143], v2, s[8:11], s26 offen offset:1024
  v_mfma_f32_16x16x32_bf16 v[40:43], v[144:147], v[56:59], v[40:43]
  v_mfma_f32_16x16x32_bf16 v[44:47], v[144:147], v[60:63], v[44:47]
  v_mfma_f32_16x16x32_bf16 v[48:51], v[144:147], v[64:67], v[48:51]
  v_mfma_f32_16x16x32_bf16 v[52:55], v[144:147], v[68:71], v[52:55]
  buffer_load_dwordx4 v[144:147], v2, s[8:11], s26 offen offset:2048
  s_add_u32 s26, s26, 3072
  s_waitcnt lgkmcnt(0)
  v_readfirstlane_b32 s32, v166
  s_cmp_lg_u32 s32, 0x1010101
  s_cbranch_scc1 cw_main_93
cr_main_94:
  ds_read_b128 v[56:59], v2 offset:24576
  ds_read_b128 v[60:63], v2 offset:25600
  ds_read_b128 v[64:67], v2 offset:26624
  ds_read_b128 v[68:71], v2 offset:27648
  s_waitcnt vmcnt(15) lgkmcnt(4)
  v_mfma_f32_16x16x32_bf16 v[8:11], v[148:151], v[72:75], v[8:11]
  v_mfma_f32_16x16x32_bf16 v[12:15], v[148:151], v[76:79], v[12:15]
  v_mfma_f32_16x16x32_bf16 v[16:19], v[148:151], v[80:83], v[16:19]
  v_mfma_f32_16x16x32_bf16 v[20:23], v[148:151], v[84:87], v[20:23]
  buffer_load_dwordx4 v[148:151], v2, s[8:11], s26 offen offset:0
  v_mfma_f32_16x16x32_bf16 v[24:27], v[152:155], v[72:75], v[24:27]
  v_mfma_f32_16x16x32_bf16 v[28:31], v[152:155], v[76:79], v[28:31]
  v_mfma_f32_16x16x32_bf16 v[32:35], v[152:155], v[80:83], v[32:35]
  v_mfma_f32_16x16x32_bf16 v[36:39], v[152:155], v[84:87], v[36:39]
  buffer_load_dwordx4 v[152:155], v2, s[8:11], s26 offen offset:1024
  v_mfma_f32_16x16x32_bf16 v[40:43], v[156:159], v[72:75], v[40:43]
  v_mfma_f32_16x16x32_bf16 v[44:47], v[156:159], v[76:79], v[44:47]
  v_mfma_f32_16x16x32_bf16 v[48:51], v[156:159], v[80:83], v[48:51]
  v_mfma_f32_16x16x32_bf16 v[52:55], v[156:159], v[84:87], v[52:55]
  buffer_load_dwordx4 v[156:159], v2, s[8:11], s26 offen offset:2048
  s_add_u32 s26, s26, 3072
  ds_read_b128 v[72:75], v2 offset:28672
  ds_read_b128 v[76:79], v2 offset:29696
  ds_read_b128 v[80:83], v2 offset:30720
  ds_read_b128 v[84:87], v2 offset:31744
  s_waitcnt vmcnt(15) lgkmcnt(4)
  v_mfma_f32_16x16x32_bf16 v[8:11], v[88:91], v[56:59], v[8:11]
  v_mfma_f32_16x16x32_bf16 v[12:15], v[88:91], v[60:63], v[12:15]
  v_mfma_f32_16x16x32_bf16 v[16:19], v[88:91], v[64:67], v[16:19]
  v_mfma_f32_16x16x32_bf16 v[20:23], v[88:91], v[68:71], v[20:23]
  buffer_load_dwordx4 v[88:91], v2, s[8:11], s26 offen offset:0
  v_mfma_f32_16x16x32_bf16 v[24:27], v[92:95], v[56:59], v[24:27]
  v_mfma_f32_16x16x32_bf16 v[28:31], v[92:95], v[60:63], v[28:31]
  v_mfma_f32_16x16x32_bf16 v[32:35], v[92:95], v[64:67], v[32:35]
  v_mfma_f32_16x16x32_bf16 v[36:39], v[92:95], v[68:71], v[36:39]
  buffer_load_dwordx4 v[92:95], v2, s[8:11], s26 offen offset:1024
  v_mfma_f32_16x16x32_bf16 v[40:43], v[96:99], v[56:59], v[40:43]
  v_mfma_f32_16x16x32_bf16 v[44:47], v[96:99], v[60:63], v[44:47]
  v_mfma_f32_16x16x32_bf16 v[48:51], v[96:99], v[64:67], v[48:51]
  v_mfma_f32_16x16x32_bf16 v[52:55], v[96:99], v[68:71], v[52:55]
  buffer_load_dwordx4 v[96:99], v2, s[8:11], s26 offen offset:2048
  s_add_u32 s26, s26, 3072
  ds_read_b128 v[56:59], v2 offset:32768
  ds_read_b128 v[60:63], v2 offset:33792
  ds_read_b128 v[64:67], v2 offset:34816
  ds_read_b128 v[68:71], v2 offset:35840
  s_waitcnt vmcnt(15) lgkmcnt(4)
  v_mfma_f32_16x16x32_bf16 v[8:11], v[100:103], v[72:75], v[8:11]
  v_mfma_f32_16x16x32_bf16 v[12:15], v[100:103], v[76:79], v[12:15]
  v_mfma_f32_16x16x32_bf16 v[16:19], v[100:103], v[80:83], v[16:19]
  v_mfma_f32_16x16x32_bf16 v[20:23], v[100:103], v[84:87], v[20:23]
  buffer_load_dwordx4 v[100:103], v2, s[8:11], s26 offen offset:0
  v_mfma_f32_16x16x32_bf16 v[24:27], v[104:107], v[72:75], v[24:27]
  v_mfma_f32_16x16x32_bf16 v[28:31], v[104:107], v[76:79], v[28:31]
  v_mfma_f32_16x16x32_bf16 v[32:35], v[104:107], v[80:83], v[32:35]
  v_mfma_f32_16x16x32_bf16 v[36:39], v[104:107], v[84:87], v[36:39]
  buffer_load_dwordx4 v[104:107], v2, s[8:11], s26 offen offset:1024
  v_mfma_f32_16x16x32_bf16 v[40:43], v[108:111], v[72:75], v[40:43]
  v_mfma_f32_16x16x32_bf16 v[44:47], v[108:111], v[76:79], v[44:47]
  v_mfma_f32_16x16x32_bf16 v[48:51], v[108:111], v[80:83], v[48:51]
  v_mfma_f32_16x16x32_bf16 v[52:55], v[108:111], v[84:87], v[52:55]
  buffer_load_dwordx4 v[108:111], v2, s[8:11], s26 offen offset:2048
  s_add_u32 s26, s26, 3072
  ds_read_b128 v[72:75], v2 offset:36864
  ds_read_b128 v[76:79], v2 offset:37888
  ds_read_b128 v[80:83], v2 offset:38912
  ds_read_b128 v[84:87], v2 offset:39936
  s_waitcnt vmcnt(15) lgkmcnt(4)
  ds_write_b8 v6, v4 offset:32
  v_mfma_f32_16x16x32_bf16 v[8:11], v[112:115], v[56:59], v[8:11]
  v_mfma_f32_16x16x32_bf16 v[12:15], v[112:115], v[60:63], v[12:15]
  v_mfma_f32_16x16x32_bf16 v[16:19], v[112:115], v[64:67], v[16:19]
  v_mfma_f32_16x16x32_bf16 v[20:23], v[112:115], v[68:71], v[20:23]
  buffer_load_dwordx4 v[112:115], v2, s[8:11], s26 offen offset:0
  v_mfma_f32_16x16x32_bf16 v[24:27], v[116:119], v[56:59], v[24:27]
  v_mfma_f32_16x16x32_bf16 v[28:31], v[116:119], v[60:63], v[28:31]
  v_mfma_f32_16x16x32_bf16 v[32:35], v[116:119], v[64:67], v[32:35]
  v_mfma_f32_16x16x32_bf16 v[36:39], v[116:119], v[68:71], v[36:39]
  buffer_load_dwordx4 v[116:119], v2, s[8:11], s26 offen offset:1024
  v_mfma_f32_16x16x32_bf16 v[40:43], v[120:123], v[56:59], v[40:43]
  v_mfma_f32_16x16x32_bf16 v[44:47], v[120:123], v[60:63], v[44:47]
  v_mfma_f32_16x16x32_bf16 v[48:51], v[120:123], v[64:67], v[48:51]
  v_mfma_f32_16x16x32_bf16 v[52:55], v[120:123], v[68:71], v[52:55]
  buffer_load_dwordx4 v[120:123], v2, s[8:11], s26 offen offset:2048
  s_add_u32 s26, s26, 3072
  ds_read_b128 v[56:59], v2 offset:40960
  ds_read_b128 v[60:63], v2 offset:41984
  ds_read_b128 v[64:67], v2 offset:43008
  ds_read_b128 v[68:71], v2 offset:44032
  s_waitcnt vmcnt(15) lgkmcnt(4)
  v_mfma_f32_16x16x32_bf16 v[8:11], v[124:127], v[72:75], v[8:11]
  v_mfma_f32_16x16x32_bf16 v[12:15], v[124:127], v[76:79], v[12:15]
  v_mfma_f32_16x16x32_bf16 v[16:19], v[124:127], v[80:83], v[16:19]
  v_mfma_f32_16x16x32_bf16 v[20:23], v[124:127], v[84:87], v[20:23]
  buffer_load_dwordx4 v[124:127], v2, s[8:11], s26 offen offset:0
  v_mfma_f32_16x16x32_bf16 v[24:27], v[128:131], v[72:75], v[24:27]
  v_mfma_f32_16x16x32_bf16 v[28:31], v[128:131], v[76:79], v[28:31]
  v_mfma_f32_16x16x32_bf16 v[32:35], v[128:131], v[80:83], v[32:35]
  v_mfma_f32_16x16x32_bf16 v[36:39], v[128:131], v[84:87], v[36:39]
  buffer_load_dwordx4 v[128:131], v2, s[8:11], s26 offen offset:1024
  v_mfma_f32_16x16x32_bf16 v[40:43], v[132:135], v[72:75], v[40:43]
  v_mfma_f32_16x16x32_bf16 v[44:47], v[132:135], v[76:79], v[44:47]
  v_mfma_f32_16x16x32_bf16 v[48:51], v[132:135], v[80:83], v[48:51]
  v_mfma_f32_16x16x32_bf16 v[52:55], v[132:135], v[84:87], v[52:55]
  buffer_load_dwordx4 v[132:135], v2, s[8:11], s26 offen offset:2048
  s_add_u32 s26, s26, 3072
  ds_read_b128 v[72:75], v2 offset:45056
  ds_read_b128 v[76:79], v2 offset:46080
  ds_read_b128 v[80:83], v2 offset:47104
  ds_read_b128 v[84:87], v2 offset:48128
  ds_read_b32 v166, v165 offset:24
  s_waitcnt vmcnt(15) lgkmcnt(5)
  v_mfma_f32_16x16x32_bf16 v[8:11], v[136:139], v[56:59], v[8:11]
  v_mfma_f32_16x16x32_bf16 v[12:15], v[136:139], v[60:63], v[12:15]
  v_mfma_f32_16x16x32_bf16 v[16:19], v[136:139], v[64:67], v[16:19]
  v_mfma_f32_16x16x32_bf16 v[20:23], v[136:139], v[68:71], v[20:23]
  buffer_load_dwordx4 v[136:139], v2, s[8:11], s26 offen offset:0
  v_mfma_f32_16x16x32_bf16 v[24:27], v[140:143], v[56:59], v[24:27]
  v_mfma_f32_16x16x32_bf16 v[28:31], v[140:143], v[60:63], v[28:31]
  v_mfma_f32_16x16x32_bf16 v[32:35], v[140:143], v[64:67], v[32:35]
  v_mfma_f32_16x16x32_bf16 v[36:39], v[140:143], v[68:71], v[36:39]
  buffer_load_dwordx4 v[140:143], v2, s[8:11], s26 offen offset:1024
  v_mfma_f32_16x16x32_bf16 v[40:43], v[144:147], v[56:59], v[40:43]
  v_mfma_f32_16x16x32_bf16 v[44:47], v[144:147], v[60:63], v[44:47]
  v_mfma_f32_16x16x32_bf16 v[48:51], v[144:147], v[64:67], v[48:51]
  v_mfma_f32_16x16x32_bf16 v[52:55], v[144:147], v[68:71], v[52:55]
  buffer_load_dwordx4 v[144:147], v2, s[8:11], s26 offen offset:2048
  s_add_u32 s26, s26, 3072
  s_waitcnt lgkmcnt(0)
  v_readfirstlane_b32 s32, v166
  s_cmp_lg_u32 s32, 0x1010101
  s_cbranch_scc1 cw_main_95
cr_main_96:
  ds_read_b128 v[56:59], v2 offset:49152
  ds_read_b128 v[60:63], v2 offset:50176
  ds_read_b128 v[64:67], v2 offset:51200
  ds_read_b128 v[68:71], v2 offset:52224
  s_waitcnt vmcnt(15) lgkmcnt(4)
  v_mfma_f32_16x16x32_bf16 v[8:11], v[148:151], v[72:75], v[8:11]
  v_mfma_f32_16x16x32_bf16 v[12:15], v[148:151], v[76:79], v[12:15]
  v_mfma_f32_16x16x32_bf16 v[16:19], v[148:151], v[80:83], v[16:19]
  v_mfma_f32_16x16x32_bf16 v[20:23], v[148:151], v[84:87], v[20:23]
  buffer_load_dwordx4 v[148:151], v2, s[8:11], s26 offen offset:0
  v_mfma_f32_16x16x32_bf16 v[24:27], v[152:155], v[72:75], v[24:27]
  v_mfma_f32_16x16x32_bf16 v[28:31], v[152:155], v[76:79], v[28:31]
  v_mfma_f32_16x16x32_bf16 v[32:35], v[152:155], v[80:83], v[32:35]
  v_mfma_f32_16x16x32_bf16 v[36:39], v[152:155], v[84:87], v[36:39]
  buffer_load_dwordx4 v[152:155], v2, s[8:11], s26 offen offset:1024
  v_mfma_f32_16x16x32_bf16 v[40:43], v[156:159], v[72:75], v[40:43]
  v_mfma_f32_16x16x32_bf16 v[44:47], v[156:159], v[76:79], v[44:47]
  v_mfma_f32_16x16x32_bf16 v[48:51], v[156:159], v[80:83], v[48:51]
  v_mfma_f32_16x16x32_bf16 v[52:55], v[156:159], v[84:87], v[52:55]
  buffer_load_dwordx4 v[156:159], v2, s[8:11], s26 offen offset:2048
  s_add_u32 s26, s26, 3072
  ds_read_b128 v[72:75], v2 offset:53248
  ds_read_b128 v[76:79], v2 offset:54272
  ds_read_b128 v[80:83], v2 offset:55296
  ds_read_b128 v[84:87], v2 offset:56320
  s_waitcnt vmcnt(15) lgkmcnt(4)
  v_mfma_f32_16x16x32_bf16 v[8:11], v[88:91], v[56:59], v[8:11]
  v_mfma_f32_16x16x32_bf16 v[12:15], v[88:91], v[60:63], v[12:15]
  v_mfma_f32_16x16x32_bf16 v[16:19], v[88:91], v[64:67], v[16:19]
  v_mfma_f32_16x16x32_bf16 v[20:23], v[88:91], v[68:71], v[20:23]
  buffer_load_dwordx2 v[88:89], v167, s[8:11], s26 offen offset:0
  buffer_load_dwordx2 v[90:91], v167, s[8:11], s26 offen offset:128
  v_mfma_f32_16x16x32_bf16 v[24:27], v[92:95], v[56:59], v[24:27]
  v_mfma_f32_16x16x32_bf16 v[28:31], v[92:95], v[60:63], v[28:31]
  v_mfma_f32_16x16x32_bf16 v[32:35], v[92:95], v[64:67], v[32:35]
  v_mfma_f32_16x16x32_bf16 v[36:39], v[92:95], v[68:71], v[36:39]
  buffer_load_dwordx2 v[92:93], v167, s[8:11], s26 offen offset:1024
  buffer_load_dwordx2 v[94:95], v167, s[8:11], s26 offen offset:1152
  v_mfma_f32_16x16x32_bf16 v[40:43], v[96:99], v[56:59], v[40:43]
  v_mfma_f32_16x16x32_bf16 v[44:47], v[96:99], v[60:63], v[44:47]
  v_mfma_f32_16x16x32_bf16 v[48:51], v[96:99], v[64:67], v[48:51]
  v_mfma_f32_16x16x32_bf16 v[52:55], v[96:99], v[68:71], v[52:55]
  buffer_load_dwordx2 v[96:97], v167, s[8:11], s26 offen offset:2048
  buffer_load_dwordx2 v[98:99], v167, s[8:11], s26 offen offset:2176
  ds_read_b128 v[56:59], v2 offset:57344
  ds_read_b128 v[60:63], v2 offset:58368
  ds_read_b128 v[64:67], v2 offset:59392
  ds_read_b128 v[68:71], v2 offset:60416
  s_waitcnt vmcnt(18) lgkmcnt(4)
  v_mfma_f32_16x16x32_bf16 v[8:11], v[100:103], v[72:75], v[8:11]
  v_mfma_f32_16x16x32_bf16 v[12:15], v[100:103], v[76:79], v[12:15]
  v_mfma_f32_16x16x32_bf16 v[16:19], v[100:103], v[80:83], v[16:19]
  v_mfma_f32_16x16x32_bf16 v[20:23], v[100:103], v[84:87], v[20:23]
  buffer_load_dwordx4 v[100:103], v2, s[8:11], s27 offen offset:0
  v_mfma_f32_16x16x32_bf16 v[24:27], v[104:107], v[72:75], v[24:27]
  v_mfma_f32_16x16x32_bf16 v[28:31], v[104:107], v[76:79], v[28:31]
  v_mfma_f32_16x16x32_bf16 v[32:35], v[104:107], v[80:83], v[32:35]
  v_mfma_f32_16x16x32_bf16 v[36:39], v[104:107], v[84:87], v[36:39]
  buffer_load_dwordx4 v[104:107], v2, s[8:11], s27 offen offset:1024
  v_mfma_f32_16x16x32_bf16 v[40:43], v[108:111], v[72:75], v[40:43]
  v_mfma_f32_16x16x32_bf16 v[44:47], v[108:111], v[76:79], v[44:47]
  v_mfma_f32_16x16x32_bf16 v[48:51], v[108:111], v[80:83], v[48:51]
  v_mfma_f32_16x16x32_bf16 v[52:55], v[108:111], v[84:87], v[52:55]
  buffer_load_dwordx4 v[108:111], v2, s[8:11], s27 offen offset:2048
  s_add_u32 s27, s27, 3072
  ds_read_b128 v[72:75], v2 offset:61440
  ds_read_b128 v[76:79], v2 offset:62464
  ds_read_b128 v[80:83], v2 offset:63488
  ds_read_b128 v[84:87], v2 offset:64512
  s_waitcnt vmcnt(18) lgkmcnt(4)
  v_mfma_f32_16x16x32_bf16 v[8:11], v[112:115], v[56:59], v[8:11]
  v_mfma_f32_16x16x32_bf16 v[12:15], v[112:115], v[60:63], v[12:15]
  v_mfma_f32_16x16x32_bf16 v[16:19], v[112:115], v[64:67], v[16:19]
  v_mfma_f32_16x16x32_bf16 v[20:23], v[112:115], v[68:71], v[20:23]
  buffer_load_dwordx4 v[112:115], v2, s[8:11], s27 offen offset:0
  v_mfma_f32_16x16x32_bf16 v[24:27], v[116:119], v[56:59], v[24:27]
  v_mfma_f32_16x16x32_bf16 v[28:31], v[116:119], v[60:63], v[28:31]
  v_mfma_f32_16x16x32_bf16 v[32:35], v[116:119], v[64:67], v[32:35]
  v_mfma_f32_16x16x32_bf16 v[36:39], v[116:119], v[68:71], v[36:39]
  buffer_load_dwordx4 v[116:119], v2, s[8:11], s27 offen offset:1024
  v_mfma_f32_16x16x32_bf16 v[40:43], v[120:123], v[56:59], v[40:43]
  v_mfma_f32_16x16x32_bf16 v[44:47], v[120:123], v[60:63], v[44:47]
  v_mfma_f32_16x16x32_bf16 v[48:51], v[120:123], v[64:67], v[48:51]
  v_mfma_f32_16x16x32_bf16 v[52:55], v[120:123], v[68:71], v[52:55]
  buffer_load_dwordx4 v[120:123], v2, s[8:11], s27 offen offset:2048
  s_add_u32 s27, s27, 3072
  ds_read_b128 v[56:59], v7 offset:0
  ds_read_b128 v[60:63], v7 offset:1024
  ds_read_b128 v[64:67], v7 offset:2048
  ds_read_b128 v[68:71], v7 offset:3072
  s_waitcnt vmcnt(18) lgkmcnt(4)
  v_mfma_f32_16x16x32_bf16 v[8:11], v[124:127], v[72:75], v[8:11]
  v_mfma_f32_16x16x32_bf16 v[12:15], v[124:127], v[76:79], v[12:15]
  v_mfma_f32_16x16x32_bf16 v[16:19], v[124:127], v[80:83], v[16:19]
  v_mfma_f32_16x16x32_bf16 v[20:23], v[124:127], v[84:87], v[20:23]
  buffer_load_dwordx4 v[124:127], v2, s[8:11], s27 offen offset:0
  v_mfma_f32_16x16x32_bf16 v[24:27], v[128:131], v[72:75], v[24:27]
  v_mfma_f32_16x16x32_bf16 v[28:31], v[128:131], v[76:79], v[28:31]
  v_mfma_f32_16x16x32_bf16 v[32:35], v[128:131], v[80:83], v[32:35]
  v_mfma_f32_16x16x32_bf16 v[36:39], v[128:131], v[84:87], v[36:39]
  buffer_load_dwordx4 v[128:131], v2, s[8:11], s27 offen offset:1024
  v_mfma_f32_16x16x32_bf16 v[40:43], v[132:135], v[72:75], v[40:43]
  v_mfma_f32_16x16x32_bf16 v[44:47], v[132:135], v[76:79], v[44:47]
  v_mfma_f32_16x16x32_bf16 v[48:51], v[132:135], v[80:83], v[48:51]
  v_mfma_f32_16x16x32_bf16 v[52:55], v[132:135], v[84:87], v[52:55]
  buffer_load_dwordx4 v[132:135], v2, s[8:11], s27 offen offset:2048
  s_add_u32 s27, s27, 3072
  ds_read_b128 v[72:75], v7 offset:4096
  ds_read_b128 v[76:79], v7 offset:5120
  ds_read_b128 v[80:83], v7 offset:6144
  ds_read_b128 v[84:87], v7 offset:7168
  ds_read_b32 v166, v165 offset:12
  s_waitcnt vmcnt(18) lgkmcnt(5)
  v_mfma_f32_16x16x32_bf16 v[8:11], v[136:139], v[56:59], v[8:11]
  v_mfma_f32_16x16x32_bf16 v[12:15], v[136:139], v[60:63], v[12:15]
  v_mfma_f32_16x16x32_bf16 v[16:19], v[136:139], v[64:67], v[16:19]
  v_mfma_f32_16x16x32_bf16 v[20:23], v[136:139], v[68:71], v[20:23]
  buffer_load_dwordx4 v[136:139], v2, s[8:11], s27 offen offset:0
  v_mfma_f32_16x16x32_bf16 v[24:27], v[140:143], v[56:59], v[24:27]
  v_mfma_f32_16x16x32_bf16 v[28:31], v[140:143], v[60:63], v[28:31]
  v_mfma_f32_16x16x32_bf16 v[32:35], v[140:143], v[64:67], v[32:35]
  v_mfma_f32_16x16x32_bf16 v[36:39], v[140:143], v[68:71], v[36:39]
  buffer_load_dwordx4 v[140:143], v2, s[8:11], s27 offen offset:1024
  v_mfma_f32_16x16x32_bf16 v[40:43], v[144:147], v[56:59], v[40:43]
  v_mfma_f32_16x16x32_bf16 v[44:47], v[144:147], v[60:63], v[44:47]
  v_mfma_f32_16x16x32_bf16 v[48:51], v[144:147], v[64:67], v[48:51]
  v_mfma_f32_16x16x32_bf16 v[52:55], v[144:147], v[68:71], v[52:55]
  buffer_load_dwordx4 v[144:147], v2, s[8:11], s27 offen offset:2048
  s_add_u32 s27, s27, 3072
  s_waitcnt lgkmcnt(0)
  v_readfirstlane_b32 s32, v166
  s_cmp_lg_u32 s32, 0x1010101
  s_cbranch_scc1 cw_main_97
cr_main_98:
  ds_read_b128 v[56:59], v7 offset:8192
  ds_read_b128 v[60:63], v7 offset:9216
  ds_read_b128 v[64:67], v7 offset:10240
  ds_read_b128 v[68:71], v7 offset:11264
  s_waitcnt vmcnt(18) lgkmcnt(4)
  v_mfma_f32_16x16x32_bf16 v[8:11], v[148:151], v[72:75], v[8:11]
  v_mfma_f32_16x16x32_bf16 v[12:15], v[148:151], v[76:79], v[12:15]
  v_mfma_f32_16x16x32_bf16 v[16:19], v[148:151], v[80:83], v[16:19]
  v_mfma_f32_16x16x32_bf16 v[20:23], v[148:151], v[84:87], v[20:23]
  buffer_load_dwordx4 v[148:151], v2, s[8:11], s27 offen offset:0
  v_mfma_f32_16x16x32_bf16 v[24:27], v[152:155], v[72:75], v[24:27]
  v_mfma_f32_16x16x32_bf16 v[28:31], v[152:155], v[76:79], v[28:31]
  v_mfma_f32_16x16x32_bf16 v[32:35], v[152:155], v[80:83], v[32:35]
  v_mfma_f32_16x16x32_bf16 v[36:39], v[152:155], v[84:87], v[36:39]
  buffer_load_dwordx4 v[152:155], v2, s[8:11], s27 offen offset:1024
  v_mfma_f32_16x16x32_bf16 v[40:43], v[156:159], v[72:75], v[40:43]
  v_mfma_f32_16x16x32_bf16 v[44:47], v[156:159], v[76:79], v[44:47]
  v_mfma_f32_16x16x32_bf16 v[48:51], v[156:159], v[80:83], v[48:51]
  v_mfma_f32_16x16x32_bf16 v[52:55], v[156:159], v[84:87], v[52:55]
  buffer_load_dwordx4 v[156:159], v2, s[8:11], s27 offen offset:2048
  s_add_u32 s27, s27, 3072
  s_waitcnt vmcnt(15) lgkmcnt(0)
  v_mfma_f32_16x16x32_bf16 v[8:11], v[88:91], v[56:59], v[8:11]
  v_mfma_f32_16x16x32_bf16 v[12:15], v[88:91], v[60:63], v[12:15]
  v_mfma_f32_16x16x32_bf16 v[16:19], v[88:91], v[64:67], v[16:19]
  v_mfma_f32_16x16x32_bf16 v[20:23], v[88:91], v[68:71], v[20:23]
  buffer_load_dwordx4 v[88:91], v2, s[8:11], s27 offen offset:0
  v_mfma_f32_16x16x32_bf16 v[24:27], v[92:95], v[56:59], v[24:27]
  v_mfma_f32_16x16x32_bf16 v[28:31], v[92:95], v[60:63], v[28:31]
  v_mfma_f32_16x16x32_bf16 v[32:35], v[92:95], v[64:67], v[32:35]
  v_mfma_f32_16x16x32_bf16 v[36:39], v[92:95], v[68:71], v[36:39]
  buffer_load_dwordx4 v[92:95], v2, s[8:11], s27 offen offset:1024
  v_mfma_f32_16x16x32_bf16 v[40:43], v[96:99], v[56:59], v[40:43]
  v_mfma_f32_16x16x32_bf16 v[44:47], v[96:99], v[60:63], v[44:47]
  v_mfma_f32_16x16x32_bf16 v[48:51], v[96:99], v[64:67], v[48:51]
  v_mfma_f32_16x16x32_bf16 v[52:55], v[96:99], v[68:71], v[52:55]
  buffer_load_dwordx4 v[96:99], v2, s[8:11], s27 offen offset:2048
  s_add_u32 s27, s27, 3072
  s_setprio 0
  v_and_b32 v56, 0xffff0000, v56
  v_and_b32 v60, 0xffff0000, v60
  v_and_b32 v64, 0xffff0000, v64
  v_and_b32 v68, 0xffff0000, v68
  v_rcp_f32 v57, v56
  v_rcp_f32 v61, v60
  v_rcp_f32 v65, v64
  v_rcp_f32 v69, v68
  v_mul_f32 v57, 0xbfb8aa3b, v57
  v_mul_f32 v61, 0xbfb8aa3b, v61
  v_mul_f32 v65, 0xbfb8aa3b, v65
  v_mul_f32 v69, 0xbfb8aa3b, v69
  s_mul_i32 s32, s3, 3
  s_add_u32 s32, s32, 0
  s_lshr_b32 s33, s32, 1
  s_lshl_b32 s33, s33, 12
  s_and_b32 s32, s32, 1
  s_lshl_b32 s32, s32, 3
  s_add_u32 s32, s32, s33
  s_add_u32 s32, s32, 77824
  v_add_u32 v4, s32, v2
  v_mul_f32 v72, v57, v8
  v_mul_f32 v73, v57, v9
  v_mul_f32 v74, v57, v10
  v_mul_f32 v75, v57, v11
  v_mul_f32 v76, v61, v12
  v_mul_f32 v77, v61, v13
  v_mul_f32 v78, v61, v14
  v_mul_f32 v79, v61, v15
  v_exp_f32 v72, v72
  v_exp_f32 v73, v73
  v_exp_f32 v74, v74
  v_exp_f32 v75, v75
  v_exp_f32 v76, v76
  v_exp_f32 v77, v77
  v_exp_f32 v78, v78
  v_exp_f32 v79, v79
  v_fma_f32 v72, v72, v56, v56
  v_fma_f32 v73, v73, v56, v56
  v_fma_f32 v74, v74, v56, v56
  v_fma_f32 v75, v75, v56, v56
  v_fma_f32 v76, v76, v60, v60
  v_fma_f32 v77, v77, v60, v60
  v_fma_f32 v78, v78, v60, v60
  v_fma_f32 v79, v79, v60, v60
  v_rcp_f32 v72, v72
  v_rcp_f32 v73, v73
  v_rcp_f32 v74, v74
  v_rcp_f32 v75, v75
  v_rcp_f32 v76, v76
  v_rcp_f32 v77, v77
  v_rcp_f32 v78, v78
  v_rcp_f32 v79, v79
  v_mul_f32 v8, v8, v72
  v_mul_f32 v9, v9, v73
  v_mul_f32 v10, v10, v74
  v_mul_f32 v11, v11, v75
  v_mul_f32 v12, v12, v76
  v_mul_f32 v13, v13, v77
  v_mul_f32 v14, v14, v78
  v_mul_f32 v15, v15, v79
  v_cvt_pk_bf16_f32 v8, v8, v9
  v_cvt_pk_bf16_f32 v9, v10, v11
  v_cvt_pk_bf16_f32 v10, v12, v13
  v_cvt_pk_bf16_f32 v11, v14, v15
  ds_write_b64 v4, v[8:9] offset:0
  ds_write_b64 v4, v[10:11] offset:1024
  v_mul_f32 v80, v65, v16
  v_mul_f32 v81, v65, v17
  v_mul_f32 v82, v65, v18
  v_mul_f32 v83, v65, v19
  v_mul_f32 v84, v69, v20
  v_mul_f32 v85, v69, v21
  v_mul_f32 v86, v69, v22
  v_mul_f32 v87, v69, v23
  v_exp_f32 v80, v80
  v_exp_f32 v81, v81
  v_exp_f32 v82, v82
  v_exp_f32 v83, v83
  v_exp_f32 v84, v84
  v_exp_f32 v85, v85
  v_exp_f32 v86, v86
  v_exp_f32 v87, v87
  v_fma_f32 v80, v80, v64, v64
  v_fma_f32 v81, v81, v64, v64
  v_fma_f32 v82, v82, v64, v64
  v_fma_f32 v83, v83, v64, v64
  v_fma_f32 v84, v84, v68, v68
  v_fma_f32 v85, v85, v68, v68
  v_fma_f32 v86, v86, v68, v68
  v_fma_f32 v87, v87, v68, v68
  v_rcp_f32 v80, v80
  v_rcp_f32 v81, v81
  v_rcp_f32 v82, v82
  v_rcp_f32 v83, v83
  v_rcp_f32 v84, v84
  v_rcp_f32 v85, v85
  v_rcp_f32 v86, v86
  v_rcp_f32 v87, v87
  v_mul_f32 v16, v16, v80
  v_mul_f32 v17, v17, v81
  v_mul_f32 v18, v18, v82
  v_mul_f32 v19, v19, v83
  v_mul_f32 v20, v20, v84
  v_mul_f32 v21, v21, v85
  v_mul_f32 v22, v22, v86
  v_mul_f32 v23, v23, v87
  v_cvt_pk_bf16_f32 v16, v16, v17
  v_cvt_pk_bf16_f32 v17, v18, v19
  v_cvt_pk_bf16_f32 v18, v20, v21
  v_cvt_pk_bf16_f32 v19, v22, v23
  ds_write_b64 v4, v[16:17] offset:2048
  ds_write_b64 v4, v[18:19] offset:3072
  s_mul_i32 s32, s3, 3
  s_add_u32 s32, s32, 1
  s_lshr_b32 s33, s32, 1
  s_lshl_b32 s33, s33, 12
  s_and_b32 s32, s32, 1
  s_lshl_b32 s32, s32, 3
  s_add_u32 s32, s32, s33
  s_add_u32 s32, s32, 77824
  v_add_u32 v5, s32, v2
  v_mul_f32 v72, v57, v24
  v_mul_f32 v73, v57, v25
  v_mul_f32 v74, v57, v26
  v_mul_f32 v75, v57, v27
  v_mul_f32 v76, v61, v28
  v_mul_f32 v77, v61, v29
  v_mul_f32 v78, v61, v30
  v_mul_f32 v79, v61, v31
  v_exp_f32 v72, v72
  v_exp_f32 v73, v73
  v_exp_f32 v74, v74
  v_exp_f32 v75, v75
  v_exp_f32 v76, v76
  v_exp_f32 v77, v77
  v_exp_f32 v78, v78
  v_exp_f32 v79, v79
  v_fma_f32 v72, v72, v56, v56
  v_fma_f32 v73, v73, v56, v56
  v_fma_f32 v74, v74, v56, v56
  v_fma_f32 v75, v75, v56, v56
  v_fma_f32 v76, v76, v60, v60
  v_fma_f32 v77, v77, v60, v60
  v_fma_f32 v78, v78, v60, v60
  v_fma_f32 v79, v79, v60, v60
  v_rcp_f32 v72, v72
  v_rcp_f32 v73, v73
  v_rcp_f32 v74, v74
  v_rcp_f32 v75, v75
  v_rcp_f32 v76, v76
  v_rcp_f32 v77, v77
  v_rcp_f32 v78, v78
  v_rcp_f32 v79, v79
  v_mul_f32 v24, v24, v72
  v_mul_f32 v25, v25, v73
  v_mul_f32 v26, v26, v74
  v_mul_f32 v27, v27, v75
  v_mul_f32 v28, v28, v76
  v_mul_f32 v29, v29, v77
  v_mul_f32 v30, v30, v78
  v_mul_f32 v31, v31, v79
  v_cvt_pk_bf16_f32 v24, v24, v25
  v_cvt_pk_bf16_f32 v25, v26, v27
  v_cvt_pk_bf16_f32 v26, v28, v29
  v_cvt_pk_bf16_f32 v27, v30, v31
  ds_write_b64 v5, v[24:25] offset:0
  ds_write_b64 v5, v[26:27] offset:1024
  v_mul_f32 v80, v65, v32
  v_mul_f32 v81, v65, v33
  v_mul_f32 v82, v65, v34
  v_mul_f32 v83, v65, v35
  v_mul_f32 v84, v69, v36
  v_mul_f32 v85, v69, v37
  v_mul_f32 v86, v69, v38
  v_mul_f32 v87, v69, v39
  v_exp_f32 v80, v80
  v_exp_f32 v81, v81
  v_exp_f32 v82, v82
  v_exp_f32 v83, v83
  v_exp_f32 v84, v84
  v_exp_f32 v85, v85
  v_exp_f32 v86, v86
  v_exp_f32 v87, v87
  v_fma_f32 v80, v80, v64, v64
  v_fma_f32 v81, v81, v64, v64
  v_fma_f32 v82, v82, v64, v64
  v_fma_f32 v83, v83, v64, v64
  v_fma_f32 v84, v84, v68, v68
  v_fma_f32 v85, v85, v68, v68
  v_fma_f32 v86, v86, v68, v68
  v_fma_f32 v87, v87, v68, v68
  v_rcp_f32 v80, v80
  v_rcp_f32 v81, v81
  v_rcp_f32 v82, v82
  v_rcp_f32 v83, v83
  v_rcp_f32 v84, v84
  v_rcp_f32 v85, v85
  v_rcp_f32 v86, v86
  v_rcp_f32 v87, v87
  v_mul_f32 v32, v32, v80
  v_mul_f32 v33, v33, v81
  v_mul_f32 v34, v34, v82
  v_mul_f32 v35, v35, v83
  v_mul_f32 v36, v36, v84
  v_mul_f32 v37, v37, v85
  v_mul_f32 v38, v38, v86
  v_mul_f32 v39, v39, v87
  v_cvt_pk_bf16_f32 v32, v32, v33
  v_cvt_pk_bf16_f32 v33, v34, v35
  v_cvt_pk_bf16_f32 v34, v36, v37
  v_cvt_pk_bf16_f32 v35, v38, v39
  ds_write_b64 v5, v[32:33] offset:2048
  ds_write_b64 v5, v[34:35] offset:3072
  s_mul_i32 s32, s3, 3
  s_add_u32 s32, s32, 2
  s_lshr_b32 s33, s32, 1
  s_lshl_b32 s33, s33, 12
  s_and_b32 s32, s32, 1
  s_lshl_b32 s32, s32, 3
  s_add_u32 s32, s32, s33
  s_add_u32 s32, s32, 77824
  v_add_u32 v4, s32, v2
  v_mul_f32 v72, v57, v40
  v_mul_f32 v73, v57, v41
  v_mul_f32 v74, v57, v42
  v_mul_f32 v75, v57, v43
  v_mul_f32 v76, v61, v44
  v_mul_f32 v77, v61, v45
  v_mul_f32 v78, v61, v46
  v_mul_f32 v79, v61, v47
  v_exp_f32 v72, v72
  v_exp_f32 v73, v73
  v_exp_f32 v74, v74
  v_exp_f32 v75, v75
  v_exp_f32 v76, v76
  v_exp_f32 v77, v77
  v_exp_f32 v78, v78
  v_exp_f32 v79, v79
  v_fma_f32 v72, v72, v56, v56
  v_fma_f32 v73, v73, v56, v56
  v_fma_f32 v74, v74, v56, v56
  v_fma_f32 v75, v75, v56, v56
  v_fma_f32 v76, v76, v60, v60
  v_fma_f32 v77, v77, v60, v60
  v_fma_f32 v78, v78, v60, v60
  v_fma_f32 v79, v79, v60, v60
  v_rcp_f32 v72, v72
  v_rcp_f32 v73, v73
  v_rcp_f32 v74, v74
  v_rcp_f32 v75, v75
  v_rcp_f32 v76, v76
  v_rcp_f32 v77, v77
  v_rcp_f32 v78, v78
  v_rcp_f32 v79, v79
  v_mul_f32 v40, v40, v72
  v_mul_f32 v41, v41, v73
  v_mul_f32 v42, v42, v74
  v_mul_f32 v43, v43, v75
  v_mul_f32 v44, v44, v76
  v_mul_f32 v45, v45, v77
  v_mul_f32 v46, v46, v78
  v_mul_f32 v47, v47, v79
  v_cvt_pk_bf16_f32 v40, v40, v41
  v_cvt_pk_bf16_f32 v41, v42, v43
  v_cvt_pk_bf16_f32 v42, v44, v45
  v_cvt_pk_bf16_f32 v43, v46, v47
  ds_write_b64 v4, v[40:41] offset:0
  ds_write_b64 v4, v[42:43] offset:1024
  v_mul_f32 v80, v65, v48
  v_mul_f32 v81, v65, v49
  v_mul_f32 v82, v65, v50
  v_mul_f32 v83, v65, v51
  v_mul_f32 v84, v69, v52
  v_mul_f32 v85, v69, v53
  v_mul_f32 v86, v69, v54
  v_mul_f32 v87, v69, v55
  v_exp_f32 v80, v80
  v_exp_f32 v81, v81
  v_exp_f32 v82, v82
  v_exp_f32 v83, v83
  v_exp_f32 v84, v84
  v_exp_f32 v85, v85
  v_exp_f32 v86, v86
  v_exp_f32 v87, v87
  v_fma_f32 v80, v80, v64, v64
  v_fma_f32 v81, v81, v64, v64
  v_fma_f32 v82, v82, v64, v64
  v_fma_f32 v83, v83, v64, v64
  v_fma_f32 v84, v84, v68, v68
  v_fma_f32 v85, v85, v68, v68
  v_fma_f32 v86, v86, v68, v68
  v_fma_f32 v87, v87, v68, v68
  v_rcp_f32 v80, v80
  v_rcp_f32 v81, v81
  v_rcp_f32 v82, v82
  v_rcp_f32 v83, v83
  v_rcp_f32 v84, v84
  v_rcp_f32 v85, v85
  v_rcp_f32 v86, v86
  v_rcp_f32 v87, v87
  v_mul_f32 v48, v48, v80
  v_mul_f32 v49, v49, v81
  v_mul_f32 v50, v50, v82
  v_mul_f32 v51, v51, v83
  v_mul_f32 v52, v52, v84
  v_mul_f32 v53, v53, v85
  v_mul_f32 v54, v54, v86
  v_mul_f32 v55, v55, v87
  v_cvt_pk_bf16_f32 v48, v48, v49
  v_cvt_pk_bf16_f32 v49, v50, v51
  v_cvt_pk_bf16_f32 v50, v52, v53
  v_cvt_pk_bf16_f32 v51, v54, v55
  ds_write_b64 v4, v[48:49] offset:2048
  ds_write_b64 v4, v[50:51] offset:3072
  v_mov_b32 v4, 1
  s_waitcnt lgkmcnt(0)
  ds_write_b8 v6, v4
  ds_read_u8 v166, v6 offset:40
  s_waitcnt lgkmcnt(0)
  v_readfirstlane_b32 s32, v166
  s_cmp_lg_u32 s32, 0x1
  s_cbranch_scc1 cw_main_99
cr_main_100:
  ds_read_b32 v166, v165 offset:0
  s_waitcnt lgkmcnt(0)
  v_readfirstlane_b32 s32, v166
  s_cmp_lg_u32 s32, 0x1010101
  s_cbranch_scc1 cw_main_101
cr_main_102:
  ds_read_b128 v[72:75], v7 offset:12288
  ds_read_b128 v[76:79], v7 offset:13312
  ds_read_b128 v[80:83], v7 offset:14336
  ds_read_b128 v[84:87], v7 offset:15360
  ds_read_b128 v[56:59], v7 offset:16384
  ds_read_b128 v[60:63], v7 offset:17408
  ds_read_b128 v[64:67], v7 offset:18432
  ds_read_b128 v[68:71], v7 offset:19456
  s_waitcnt vmcnt(15) lgkmcnt(4)
  v_mfma_f32_16x16x32_bf16 v[8:11], v[100:103], v[72:75], 0
  v_mfma_f32_16x16x32_bf16 v[12:15], v[100:103], v[76:79], 0
  v_mfma_f32_16x16x32_bf16 v[16:19], v[100:103], v[80:83], 0
  v_mfma_f32_16x16x32_bf16 v[20:23], v[100:103], v[84:87], 0
  buffer_load_dwordx4 v[100:103], v2, s[8:11], s27 offen offset:0
  v_mfma_f32_16x16x32_bf16 v[24:27], v[104:107], v[72:75], 0
  v_mfma_f32_16x16x32_bf16 v[28:31], v[104:107], v[76:79], 0
  v_mfma_f32_16x16x32_bf16 v[32:35], v[104:107], v[80:83], 0
  v_mfma_f32_16x16x32_bf16 v[36:39], v[104:107], v[84:87], 0
  buffer_load_dwordx4 v[104:107], v2, s[8:11], s27 offen offset:1024
  v_mfma_f32_16x16x32_bf16 v[40:43], v[108:111], v[72:75], 0
  v_mfma_f32_16x16x32_bf16 v[44:47], v[108:111], v[76:79], 0
  v_mfma_f32_16x16x32_bf16 v[48:51], v[108:111], v[80:83], 0
  v_mfma_f32_16x16x32_bf16 v[52:55], v[108:111], v[84:87], 0
  buffer_load_dwordx4 v[108:111], v2, s[8:11], s27 offen offset:2048
  s_add_u32 s27, s27, 3072
  ds_read_b128 v[72:75], v7 offset:20480
  ds_read_b128 v[76:79], v7 offset:21504
  ds_read_b128 v[80:83], v7 offset:22528
  ds_read_b128 v[84:87], v7 offset:23552
  s_waitcnt vmcnt(15) lgkmcnt(4)
  v_mfma_f32_16x16x32_bf16 v[8:11], v[112:115], v[56:59], v[8:11]
  v_mfma_f32_16x16x32_bf16 v[12:15], v[112:115], v[60:63], v[12:15]
  v_mfma_f32_16x16x32_bf16 v[16:19], v[112:115], v[64:67], v[16:19]
  v_mfma_f32_16x16x32_bf16 v[20:23], v[112:115], v[68:71], v[20:23]
  buffer_load_dwordx4 v[112:115], v2, s[8:11], s27 offen offset:0
  v_mfma_f32_16x16x32_bf16 v[24:27], v[116:119], v[56:59], v[24:27]
  v_mfma_f32_16x16x32_bf16 v[28:31], v[116:119], v[60:63], v[28:31]
  v_mfma_f32_16x16x32_bf16 v[32:35], v[116:119], v[64:67], v[32:35]
  v_mfma_f32_16x16x32_bf16 v[36:39], v[116:119], v[68:71], v[36:39]
  buffer_load_dwordx4 v[116:119], v2, s[8:11], s27 offen offset:1024
  v_mfma_f32_16x16x32_bf16 v[40:43], v[120:123], v[56:59], v[40:43]
  v_mfma_f32_16x16x32_bf16 v[44:47], v[120:123], v[60:63], v[44:47]
  v_mfma_f32_16x16x32_bf16 v[48:51], v[120:123], v[64:67], v[48:51]
  v_mfma_f32_16x16x32_bf16 v[52:55], v[120:123], v[68:71], v[52:55]
  buffer_load_dwordx4 v[120:123], v2, s[8:11], s27 offen offset:2048
  s_add_u32 s27, s27, 3072
  ds_read_b128 v[56:59], v7 offset:24576
  ds_read_b128 v[60:63], v7 offset:25600
  ds_read_b128 v[64:67], v7 offset:26624
  ds_read_b128 v[68:71], v7 offset:27648
  s_waitcnt vmcnt(15) lgkmcnt(4)
  v_mfma_f32_16x16x32_bf16 v[8:11], v[124:127], v[72:75], v[8:11]
  v_mfma_f32_16x16x32_bf16 v[12:15], v[124:127], v[76:79], v[12:15]
  v_mfma_f32_16x16x32_bf16 v[16:19], v[124:127], v[80:83], v[16:19]
  v_mfma_f32_16x16x32_bf16 v[20:23], v[124:127], v[84:87], v[20:23]
  buffer_load_dwordx4 v[124:127], v2, s[8:11], s27 offen offset:0
  v_mfma_f32_16x16x32_bf16 v[24:27], v[128:131], v[72:75], v[24:27]
  v_mfma_f32_16x16x32_bf16 v[28:31], v[128:131], v[76:79], v[28:31]
  v_mfma_f32_16x16x32_bf16 v[32:35], v[128:131], v[80:83], v[32:35]
  v_mfma_f32_16x16x32_bf16 v[36:39], v[128:131], v[84:87], v[36:39]
  buffer_load_dwordx4 v[128:131], v2, s[8:11], s27 offen offset:1024
  v_mfma_f32_16x16x32_bf16 v[40:43], v[132:135], v[72:75], v[40:43]
  v_mfma_f32_16x16x32_bf16 v[44:47], v[132:135], v[76:79], v[44:47]
  v_mfma_f32_16x16x32_bf16 v[48:51], v[132:135], v[80:83], v[48:51]
  v_mfma_f32_16x16x32_bf16 v[52:55], v[132:135], v[84:87], v[52:55]
  buffer_load_dwordx4 v[132:135], v2, s[8:11], s27 offen offset:2048
  s_add_u32 s27, s27, 3072
  ds_read_b128 v[72:75], v7 offset:28672
  ds_read_b128 v[76:79], v7 offset:29696
  ds_read_b128 v[80:83], v7 offset:30720
  ds_read_b128 v[84:87], v7 offset:31744
  s_waitcnt vmcnt(15) lgkmcnt(4)
  v_mfma_f32_16x16x32_bf16 v[8:11], v[136:139], v[56:59], v[8:11]
  v_mfma_f32_16x16x32_bf16 v[12:15], v[136:139], v[60:63], v[12:15]
  v_mfma_f32_16x16x32_bf16 v[16:19], v[136:139], v[64:67], v[16:19]
  v_mfma_f32_16x16x32_bf16 v[20:23], v[136:139], v[68:71], v[20:23]
  buffer_load_dwordx4 v[136:139], v2, s[8:11], s27 offen offset:0
  v_mfma_f32_16x16x32_bf16 v[24:27], v[140:143], v[56:59], v[24:27]
  v_mfma_f32_16x16x32_bf16 v[28:31], v[140:143], v[60:63], v[28:31]
  v_mfma_f32_16x16x32_bf16 v[32:35], v[140:143], v[64:67], v[32:35]
  v_mfma_f32_16x16x32_bf16 v[36:39], v[140:143], v[68:71], v[36:39]
  buffer_load_dwordx4 v[140:143], v2, s[8:11], s27 offen offset:1024
  v_mfma_f32_16x16x32_bf16 v[40:43], v[144:147], v[56:59], v[40:43]
  v_mfma_f32_16x16x32_bf16 v[44:47], v[144:147], v[60:63], v[44:47]
  v_mfma_f32_16x16x32_bf16 v[48:51], v[144:147], v[64:67], v[48:51]
  v_mfma_f32_16x16x32_bf16 v[52:55], v[144:147], v[68:71], v[52:55]
  buffer_load_dwordx4 v[144:147], v2, s[8:11], s27 offen offset:2048
  s_add_u32 s27, s27, 3072
  ds_read_b128 v[56:59], v7 offset:32768
  ds_read_b128 v[60:63], v7 offset:33792
  ds_read_b128 v[64:67], v7 offset:34816
  ds_read_b128 v[68:71], v7 offset:35840
  ds_read_b32 v166, v165 offset:4
  s_waitcnt vmcnt(15) lgkmcnt(5)
  v_mfma_f32_16x16x32_bf16 v[8:11], v[148:151], v[72:75], v[8:11]
  v_mfma_f32_16x16x32_bf16 v[12:15], v[148:151], v[76:79], v[12:15]
  v_mfma_f32_16x16x32_bf16 v[16:19], v[148:151], v[80:83], v[16:19]
  v_mfma_f32_16x16x32_bf16 v[20:23], v[148:151], v[84:87], v[20:23]
  buffer_load_dwordx4 v[148:151], v2, s[8:11], s27 offen offset:0
  v_mfma_f32_16x16x32_bf16 v[24:27], v[152:155], v[72:75], v[24:27]
  v_mfma_f32_16x16x32_bf16 v[28:31], v[152:155], v[76:79], v[28:31]
  v_mfma_f32_16x16x32_bf16 v[32:35], v[152:155], v[80:83], v[32:35]
  v_mfma_f32_16x16x32_bf16 v[36:39], v[152:155], v[84:87], v[36:39]
  buffer_load_dwordx4 v[152:155], v2, s[8:11], s27 offen offset:1024
  v_mfma_f32_16x16x32_bf16 v[40:43], v[156:159], v[72:75], v[40:43]
  v_mfma_f32_16x16x32_bf16 v[44:47], v[156:159], v[76:79], v[44:47]
  v_mfma_f32_16x16x32_bf16 v[48:51], v[156:159], v[80:83], v[48:51]
  v_mfma_f32_16x16x32_bf16 v[52:55], v[156:159], v[84:87], v[52:55]
  buffer_load_dwordx4 v[156:159], v2, s[8:11], s27 offen offset:2048
  s_add_u32 s27, s27, 3072
  s_waitcnt lgkmcnt(0)
  v_readfirstlane_b32 s32, v166
  s_cmp_lg_u32 s32, 0x1010101
  s_cbranch_scc1 cw_main_103
cr_main_104:
  ds_read_b128 v[72:75], v7 offset:36864
  ds_read_b128 v[76:79], v7 offset:37888
  ds_read_b128 v[80:83], v7 offset:38912
  ds_read_b128 v[84:87], v7 offset:39936
  s_waitcnt vmcnt(15) lgkmcnt(4)
  v_mfma_f32_16x16x32_bf16 v[8:11], v[88:91], v[56:59], v[8:11]
  v_mfma_f32_16x16x32_bf16 v[12:15], v[88:91], v[60:63], v[12:15]
  v_mfma_f32_16x16x32_bf16 v[16:19], v[88:91], v[64:67], v[16:19]
  v_mfma_f32_16x16x32_bf16 v[20:23], v[88:91], v[68:71], v[20:23]
  buffer_load_dwordx4 v[88:91], v2, s[8:11], s27 offen offset:0
  v_mfma_f32_16x16x32_bf16 v[24:27], v[92:95], v[56:59], v[24:27]
  v_mfma_f32_16x16x32_bf16 v[28:31], v[92:95], v[60:63], v[28:31]
  v_mfma_f32_16x16x32_bf16 v[32:35], v[92:95], v[64:67], v[32:35]
  v_mfma_f32_16x16x32_bf16 v[36:39], v[92:95], v[68:71], v[36:39]
  buffer_load_dwordx4 v[92:95], v2, s[8:11], s27 offen offset:1024
  v_mfma_f32_16x16x32_bf16 v[40:43], v[96:99], v[56:59], v[40:43]
  v_mfma_f32_16x16x32_bf16 v[44:47], v[96:99], v[60:63], v[44:47]
  v_mfma_f32_16x16x32_bf16 v[48:51], v[96:99], v[64:67], v[48:51]
  v_mfma_f32_16x16x32_bf16 v[52:55], v[96:99], v[68:71], v[52:55]
  buffer_load_dwordx4 v[96:99], v2, s[8:11], s27 offen offset:2048
  s_add_u32 s27, s27, 3072
  ds_read_b128 v[56:59], v7 offset:40960
  ds_read_b128 v[60:63], v7 offset:41984
  ds_read_b128 v[64:67], v7 offset:43008
  ds_read_b128 v[68:71], v7 offset:44032
  s_waitcnt vmcnt(15) lgkmcnt(4)
  v_mfma_f32_16x16x32_bf16 v[8:11], v[100:103], v[72:75], v[8:11]
  v_mfma_f32_16x16x32_bf16 v[12:15], v[100:103], v[76:79], v[12:15]
  v_mfma_f32_16x16x32_bf16 v[16:19], v[100:103], v[80:83], v[16:19]
  v_mfma_f32_16x16x32_bf16 v[20:23], v[100:103], v[84:87], v[20:23]
  buffer_load_dwordx4 v[100:103], v2, s[8:11], s27 offen offset:0
  v_mfma_f32_16x16x32_bf16 v[24:27], v[104:107], v[72:75], v[24:27]
  v_mfma_f32_16x16x32_bf16 v[28:31], v[104:107], v[76:79], v[28:31]
  v_mfma_f32_16x16x32_bf16 v[32:35], v[104:107], v[80:83], v[32:35]
  v_mfma_f32_16x16x32_bf16 v[36:39], v[104:107], v[84:87], v[36:39]
  buffer_load_dwordx4 v[104:107], v2, s[8:11], s27 offen offset:1024
  v_mfma_f32_16x16x32_bf16 v[40:43], v[108:111], v[72:75], v[40:43]
  v_mfma_f32_16x16x32_bf16 v[44:47], v[108:111], v[76:79], v[44:47]
  v_mfma_f32_16x16x32_bf16 v[48:51], v[108:111], v[80:83], v[48:51]
  v_mfma_f32_16x16x32_bf16 v[52:55], v[108:111], v[84:87], v[52:55]
  buffer_load_dwordx4 v[108:111], v2, s[8:11], s27 offen offset:2048
  s_add_u32 s27, s27, 3072
  ds_read_b128 v[72:75], v7 offset:45056
  ds_read_b128 v[76:79], v7 offset:46080
  ds_read_b128 v[80:83], v7 offset:47104
  ds_read_b128 v[84:87], v7 offset:48128
  s_waitcnt vmcnt(15) lgkmcnt(4)
  v_mfma_f32_16x16x32_bf16 v[8:11], v[112:115], v[56:59], v[8:11]
  v_mfma_f32_16x16x32_bf16 v[12:15], v[112:115], v[60:63], v[12:15]
  v_mfma_f32_16x16x32_bf16 v[16:19], v[112:115], v[64:67], v[16:19]
  v_mfma_f32_16x16x32_bf16 v[20:23], v[112:115], v[68:71], v[20:23]
  buffer_load_dwordx4 v[112:115], v2, s[8:11], s27 offen offset:0
  v_mfma_f32_16x16x32_bf16 v[24:27], v[116:119], v[56:59], v[24:27]
  v_mfma_f32_16x16x32_bf16 v[28:31], v[116:119], v[60:63], v[28:31]
  v_mfma_f32_16x16x32_bf16 v[32:35], v[116:119], v[64:67], v[32:35]
  v_mfma_f32_16x16x32_bf16 v[36:39], v[116:119], v[68:71], v[36:39]
  buffer_load_dwordx4 v[116:119], v2, s[8:11], s27 offen offset:1024
  v_mfma_f32_16x16x32_bf16 v[40:43], v[120:123], v[56:59], v[40:43]
  v_mfma_f32_16x16x32_bf16 v[44:47], v[120:123], v[60:63], v[44:47]
  v_mfma_f32_16x16x32_bf16 v[48:51], v[120:123], v[64:67], v[48:51]
  v_mfma_f32_16x16x32_bf16 v[52:55], v[120:123], v[68:71], v[52:55]
  buffer_load_dwordx4 v[120:123], v2, s[8:11], s27 offen offset:2048
  s_add_u32 s27, s27, 3072
  ds_read_b128 v[56:59], v7 offset:49152
  ds_read_b128 v[60:63], v7 offset:50176
  ds_read_b128 v[64:67], v7 offset:51200
  ds_read_b128 v[68:71], v7 offset:52224
  s_waitcnt vmcnt(15) lgkmcnt(4)
  ds_write_b8 v6, v4 offset:44
  v_mfma_f32_16x16x32_bf16 v[8:11], v[124:127], v[72:75], v[8:11]
  v_mfma_f32_16x16x32_bf16 v[12:15], v[124:127], v[76:79], v[12:15]
  v_mfma_f32_16x16x32_bf16 v[16:19], v[124:127], v[80:83], v[16:19]
  v_mfma_f32_16x16x32_bf16 v[20:23], v[124:127], v[84:87], v[20:23]
  buffer_load_dwordx4 v[124:127], v2, s[8:11], s27 offen offset:0
  v_mfma_f32_16x16x32_bf16 v[24:27], v[128:131], v[72:75], v[24:27]
  v_mfma_f32_16x16x32_bf16 v[28:31], v[128:131], v[76:79], v[28:31]
  v_mfma_f32_16x16x32_bf16 v[32:35], v[128:131], v[80:83], v[32:35]
  v_mfma_f32_16x16x32_bf16 v[36:39], v[128:131], v[84:87], v[36:39]
  buffer_load_dwordx4 v[128:131], v2, s[8:11], s27 offen offset:1024
  v_mfma_f32_16x16x32_bf16 v[40:43], v[132:135], v[72:75], v[40:43]
  v_mfma_f32_16x16x32_bf16 v[44:47], v[132:135], v[76:79], v[44:47]
  v_mfma_f32_16x16x32_bf16 v[48:51], v[132:135], v[80:83], v[48:51]
  v_mfma_f32_16x16x32_bf16 v[52:55], v[132:135], v[84:87], v[52:55]
  buffer_load_dwordx4 v[132:135], v2, s[8:11], s27 offen offset:2048
  s_add_u32 s27, s27, 3072
  ds_read_b128 v[72:75], v7 offset:53248
  ds_read_b128 v[76:79], v7 offset:54272
  ds_read_b128 v[80:83], v7 offset:55296
  ds_read_b128 v[84:87], v7 offset:56320
  s_waitcnt vmcnt(15) lgkmcnt(4)
  v_mfma_f32_16x16x32_bf16 v[8:11], v[136:139], v[56:59], v[8:11]
  v_mfma_f32_16x16x32_bf16 v[12:15], v[136:139], v[60:63], v[12:15]
  v_mfma_f32_16x16x32_bf16 v[16:19], v[136:139], v[64:67], v[16:19]
  v_mfma_f32_16x16x32_bf16 v[20:23], v[136:139], v[68:71], v[20:23]
  buffer_load_dwordx4 v[136:139], v2, s[8:11], s27 offen offset:0
  v_mfma_f32_16x16x32_bf16 v[24:27], v[140:143], v[56:59], v[24:27]
  v_mfma_f32_16x16x32_bf16 v[28:31], v[140:143], v[60:63], v[28:31]
  v_mfma_f32_16x16x32_bf16 v[32:35], v[140:143], v[64:67], v[32:35]
  v_mfma_f32_16x16x32_bf16 v[36:39], v[140:143], v[68:71], v[36:39]
  buffer_load_dwordx4 v[140:143], v2, s[8:11], s27 offen offset:1024
  v_mfma_f32_16x16x32_bf16 v[40:43], v[144:147], v[56:59], v[40:43]
  v_mfma_f32_16x16x32_bf16 v[44:47], v[144:147], v[60:63], v[44:47]
  v_mfma_f32_16x16x32_bf16 v[48:51], v[144:147], v[64:67], v[48:51]
  v_mfma_f32_16x16x32_bf16 v[52:55], v[144:147], v[68:71], v[52:55]
  buffer_load_dwordx4 v[144:147], v2, s[8:11], s27 offen offset:2048
  s_add_u32 s27, s27, 3072
  ds_read_b128 v[56:59], v7 offset:57344
  ds_read_b128 v[60:63], v7 offset:58368
  ds_read_b128 v[64:67], v7 offset:59392
  ds_read_b128 v[68:71], v7 offset:60416
  ds_read_b32 v166, v165 offset:8
  s_waitcnt vmcnt(15) lgkmcnt(5)
  v_mfma_f32_16x16x32_bf16 v[8:11], v[148:151], v[72:75], v[8:11]
  v_mfma_f32_16x16x32_bf16 v[12:15], v[148:151], v[76:79], v[12:15]
  v_mfma_f32_16x16x32_bf16 v[16:19], v[148:151], v[80:83], v[16:19]
  v_mfma_f32_16x16x32_bf16 v[20:23], v[148:151], v[84:87], v[20:23]
  buffer_load_dwordx4 v[148:151], v2, s[8:11], s27 offen offset:0
  v_mfma_f32_16x16x32_bf16 v[24:27], v[152:155], v[72:75], v[24:27]
  v_mfma_f32_16x16x32_bf16 v[28:31], v[152:155], v[76:79], v[28:31]
  v_mfma_f32_16x16x32_bf16 v[32:35], v[152:155], v[80:83], v[32:35]
  v_mfma_f32_16x16x32_bf16 v[36:39], v[152:155], v[84:87], v[36:39]
  buffer_load_dwordx4 v[152:155], v2, s[8:11], s27 offen offset:1024
  v_mfma_f32_16x16x32_bf16 v[40:43], v[156:159], v[72:75], v[40:43]
  v_mfma_f32_16x16x32_bf16 v[44:47], v[156:159], v[76:79], v[44:47]
  v_mfma_f32_16x16x32_bf16 v[48:51], v[156:159], v[80:83], v[48:51]
  v_mfma_f32_16x16x32_bf16 v[52:55], v[156:159], v[84:87], v[52:55]
  buffer_load_dwordx4 v[156:159], v2, s[8:11], s27 offen offset:2048
  s_add_u32 s27, s27, 3072
  s_waitcnt lgkmcnt(0)
  v_readfirstlane_b32 s32, v166
  s_cmp_lg_u32 s32, 0x1010101
  s_cbranch_scc1 cw_main_105
cr_main_106:
  ds_read_b128 v[72:75], v7 offset:61440
  ds_read_b128 v[76:79], v7 offset:62464
  ds_read_b128 v[80:83], v7 offset:63488
  ds_read_b128 v[84:87], v7 offset:64512
  s_waitcnt vmcnt(15) lgkmcnt(4)
  v_mfma_f32_16x16x32_bf16 v[8:11], v[88:91], v[56:59], v[8:11]
  v_mfma_f32_16x16x32_bf16 v[12:15], v[88:91], v[60:63], v[12:15]
  v_mfma_f32_16x16x32_bf16 v[16:19], v[88:91], v[64:67], v[16:19]
  v_mfma_f32_16x16x32_bf16 v[20:23], v[88:91], v[68:71], v[20:23]
  buffer_load_dwordx4 v[88:91], v2, s[8:11], s27 offen offset:0
  v_mfma_f32_16x16x32_bf16 v[24:27], v[92:95], v[56:59], v[24:27]
  v_mfma_f32_16x16x32_bf16 v[28:31], v[92:95], v[60:63], v[28:31]
  v_mfma_f32_16x16x32_bf16 v[32:35], v[92:95], v[64:67], v[32:35]
  v_mfma_f32_16x16x32_bf16 v[36:39], v[92:95], v[68:71], v[36:39]
  buffer_load_dwordx4 v[92:95], v2, s[8:11], s27 offen offset:1024
  v_mfma_f32_16x16x32_bf16 v[40:43], v[96:99], v[56:59], v[40:43]
  v_mfma_f32_16x16x32_bf16 v[44:47], v[96:99], v[60:63], v[44:47]
  v_mfma_f32_16x16x32_bf16 v[48:51], v[96:99], v[64:67], v[48:51]
  v_mfma_f32_16x16x32_bf16 v[52:55], v[96:99], v[68:71], v[52:55]
  buffer_load_dwordx4 v[96:99], v2, s[8:11], s27 offen offset:2048
  ds_read_b128 v[56:59], v3 offset:0
  ds_read_b128 v[60:63], v3 offset:1024
  ds_read_b128 v[64:67], v3 offset:2048
  ds_read_b128 v[68:71], v3 offset:3072
  s_waitcnt vmcnt(15) lgkmcnt(4)
  ds_write_b8 v6, v4 offset:64
  v_mfma_f32_16x16x32_bf16 v[8:11], v[100:103], v[72:75], v[8:11]
  v_mfma_f32_16x16x32_bf16 v[12:15], v[100:103], v[76:79], v[12:15]
  v_mfma_f32_16x16x32_bf16 v[16:19], v[100:103], v[80:83], v[16:19]
  v_mfma_f32_16x16x32_bf16 v[20:23], v[100:103], v[84:87], v[20:23]
  v_mfma_f32_16x16x32_bf16 v[24:27], v[104:107], v[72:75], v[24:27]
  v_mfma_f32_16x16x32_bf16 v[28:31], v[104:107], v[76:79], v[28:31]
  v_mfma_f32_16x16x32_bf16 v[32:35], v[104:107], v[80:83], v[32:35]
  v_mfma_f32_16x16x32_bf16 v[36:39], v[104:107], v[84:87], v[36:39]
  v_mfma_f32_16x16x32_bf16 v[40:43], v[108:111], v[72:75], v[40:43]
  v_mfma_f32_16x16x32_bf16 v[44:47], v[108:111], v[76:79], v[44:47]
  v_mfma_f32_16x16x32_bf16 v[48:51], v[108:111], v[80:83], v[48:51]
  v_mfma_f32_16x16x32_bf16 v[52:55], v[108:111], v[84:87], v[52:55]
  ds_read_b128 v[72:75], v3 offset:4096
  ds_read_b128 v[76:79], v3 offset:5120
  ds_read_b128 v[80:83], v3 offset:6144
  ds_read_b128 v[84:87], v3 offset:7168
  s_waitcnt vmcnt(12) lgkmcnt(4)
  v_mfma_f32_16x16x32_bf16 v[8:11], v[112:115], v[56:59], v[8:11]
  v_mfma_f32_16x16x32_bf16 v[12:15], v[112:115], v[60:63], v[12:15]
  v_mfma_f32_16x16x32_bf16 v[16:19], v[112:115], v[64:67], v[16:19]
  v_mfma_f32_16x16x32_bf16 v[20:23], v[112:115], v[68:71], v[20:23]
  v_mfma_f32_16x16x32_bf16 v[24:27], v[116:119], v[56:59], v[24:27]
  v_mfma_f32_16x16x32_bf16 v[28:31], v[116:119], v[60:63], v[28:31]
  v_mfma_f32_16x16x32_bf16 v[32:35], v[116:119], v[64:67], v[32:35]
  v_mfma_f32_16x16x32_bf16 v[36:39], v[116:119], v[68:71], v[36:39]
  v_mfma_f32_16x16x32_bf16 v[40:43], v[120:123], v[56:59], v[40:43]
  v_mfma_f32_16x16x32_bf16 v[44:47], v[120:123], v[60:63], v[44:47]
  v_mfma_f32_16x16x32_bf16 v[48:51], v[120:123], v[64:67], v[48:51]
  v_mfma_f32_16x16x32_bf16 v[52:55], v[120:123], v[68:71], v[52:55]
  ds_read_b128 v[56:59], v3 offset:8192
  ds_read_b128 v[60:63], v3 offset:9216
  ds_read_b128 v[64:67], v3 offset:10240
  ds_read_b128 v[68:71], v3 offset:11264
  s_waitcnt vmcnt(9) lgkmcnt(4)
  v_mfma_f32_16x16x32_bf16 v[8:11], v[124:127], v[72:75], v[8:11]
  v_mfma_f32_16x16x32_bf16 v[12:15], v[124:127], v[76:79], v[12:15]
  v_mfma_f32_16x16x32_bf16 v[16:19], v[124:127], v[80:83], v[16:19]
  v_mfma_f32_16x16x32_bf16 v[20:23], v[124:127], v[84:87], v[20:23]
  v_mfma_f32_16x16x32_bf16 v[24:27], v[128:131], v[72:75], v[24:27]
  v_mfma_f32_16x16x32_bf16 v[28:31], v[128:131], v[76:79], v[28:31]
  v_mfma_f32_16x16x32_bf16 v[32:35], v[128:131], v[80:83], v[32:35]
  v_mfma_f32_16x16x32_bf16 v[36:39], v[128:131], v[84:87], v[36:39]
  v_mfma_f32_16x16x32_bf16 v[40:43], v[132:135], v[72:75], v[40:43]
  v_mfma_f32_16x16x32_bf16 v[44:47], v[132:135], v[76:79], v[44:47]
  v_mfma_f32_16x16x32_bf16 v[48:51], v[132:135], v[80:83], v[48:51]
  v_mfma_f32_16x16x32_bf16 v[52:55], v[132:135], v[84:87], v[52:55]
  ds_read_b128 v[72:75], v3 offset:12288
  ds_read_b128 v[76:79], v3 offset:13312
  ds_read_b128 v[80:83], v3 offset:14336
  ds_read_b128 v[84:87], v3 offset:15360
  s_waitcnt vmcnt(6) lgkmcnt(4)
  v_mfma_f32_16x16x32_bf16 v[8:11], v[136:139], v[56:59], v[8:11]
  v_mfma_f32_16x16x32_bf16 v[12:15], v[136:139], v[60:63], v[12:15]
  v_mfma_f32_16x16x32_bf16 v[16:19], v[136:139], v[64:67], v[16:19]
  v_mfma_f32_16x16x32_bf16 v[20:23], v[136:139], v[68:71], v[20:23]
  v_mfma_f32_16x16x32_bf16 v[24:27], v[140:143], v[56:59], v[24:27]
  v_mfma_f32_16x16x32_bf16 v[28:31], v[140:143], v[60:63], v[28:31]
  v_mfma_f32_16x16x32_bf16 v[32:35], v[140:143], v[64:67], v[32:35]
  v_mfma_f32_16x16x32_bf16 v[36:39], v[140:143], v[68:71], v[36:39]
  v_mfma_f32_16x16x32_bf16 v[40:43], v[144:147], v[56:59], v[40:43]
  v_mfma_f32_16x16x32_bf16 v[44:47], v[144:147], v[60:63], v[44:47]
  v_mfma_f32_16x16x32_bf16 v[48:51], v[144:147], v[64:67], v[48:51]
  v_mfma_f32_16x16x32_bf16 v[52:55], v[144:147], v[68:71], v[52:55]
  ds_read_b128 v[56:59], v3 offset:16384
  ds_read_b128 v[60:63], v3 offset:17408
  ds_read_b128 v[64:67], v3 offset:18432
  ds_read_b128 v[68:71], v3 offset:19456
  s_waitcnt vmcnt(3) lgkmcnt(4)
  v_mfma_f32_16x16x32_bf16 v[8:11], v[148:151], v[72:75], v[8:11]
  v_mfma_f32_16x16x32_bf16 v[12:15], v[148:151], v[76:79], v[12:15]
  v_mfma_f32_16x16x32_bf16 v[16:19], v[148:151], v[80:83], v[16:19]
  v_mfma_f32_16x16x32_bf16 v[20:23], v[148:151], v[84:87], v[20:23]
  v_mfma_f32_16x16x32_bf16 v[24:27], v[152:155], v[72:75], v[24:27]
  v_mfma_f32_16x16x32_bf16 v[28:31], v[152:155], v[76:79], v[28:31]
  v_mfma_f32_16x16x32_bf16 v[32:35], v[152:155], v[80:83], v[32:35]
  v_mfma_f32_16x16x32_bf16 v[36:39], v[152:155], v[84:87], v[36:39]
  v_mfma_f32_16x16x32_bf16 v[40:43], v[156:159], v[72:75], v[40:43]
  v_mfma_f32_16x16x32_bf16 v[44:47], v[156:159], v[76:79], v[44:47]
  v_mfma_f32_16x16x32_bf16 v[48:51], v[156:159], v[80:83], v[48:51]
  v_mfma_f32_16x16x32_bf16 v[52:55], v[156:159], v[84:87], v[52:55]
  s_waitcnt vmcnt(0) lgkmcnt(0)
  v_mfma_f32_16x16x32_bf16 v[8:11], v[88:91], v[56:59], v[8:11]
  v_mfma_f32_16x16x32_bf16 v[12:15], v[88:91], v[60:63], v[12:15]
  v_mfma_f32_16x16x32_bf16 v[16:19], v[88:91], v[64:67], v[16:19]
  v_mfma_f32_16x16x32_bf16 v[20:23], v[88:91], v[68:71], v[20:23]
  v_mfma_f32_16x16x32_bf16 v[24:27], v[92:95], v[56:59], v[24:27]
  v_mfma_f32_16x16x32_bf16 v[28:31], v[92:95], v[60:63], v[28:31]
  v_mfma_f32_16x16x32_bf16 v[32:35], v[92:95], v[64:67], v[32:35]
  v_mfma_f32_16x16x32_bf16 v[36:39], v[92:95], v[68:71], v[36:39]
  v_mfma_f32_16x16x32_bf16 v[40:43], v[96:99], v[56:59], v[40:43]
  v_mfma_f32_16x16x32_bf16 v[44:47], v[96:99], v[60:63], v[44:47]
  v_mfma_f32_16x16x32_bf16 v[48:51], v[96:99], v[64:67], v[48:51]
  v_mfma_f32_16x16x32_bf16 v[52:55], v[96:99], v[68:71], v[52:55]
  ds_write_b8 v6, v4 offset:76
  s_setprio 2
  s_mul_i32 s32, s23, 3
  s_add_u32 s32, s32, s22
  s_mul_i32 s32, s32, 3
  s_mul_i32 s33, s21, 72
  s_add_u32 s32, s32, s33
  s_lshl3_add_u32 s32, s32, s20
  s_lshl_b32 s32, s32, 10
  s_add_u32 s32, s32, 29097984
  v_cvt_pk_bf16_f32 v88, v8, v9
  v_cvt_pk_bf16_f32 v89, v10, v11
  v_cvt_pk_bf16_f32 v90, v12, v13
  v_cvt_pk_bf16_f32 v91, v14, v15
  s_add_u32 s33, s32, 0
  buffer_store_dwordx4 v[88:91], v2, s[8:11], s33 offen sc1
  s_cmp_eq_u32 s22, 2
  s_cbranch_scc1 nt_main_107
  s_waitcnt vmcnt(1)
nt_main_107:
  v_cvt_pk_bf16_f32 v92, v16, v17
  v_cvt_pk_bf16_f32 v93, v18, v19
  v_cvt_pk_bf16_f32 v94, v20, v21
  v_cvt_pk_bf16_f32 v95, v22, v23
  s_add_u32 s33, s32, 294912
  buffer_store_dwordx4 v[92:95], v2, s[8:11], s33 offen sc1
  s_cmp_eq_u32 s22, 2
  s_cbranch_scc1 nt_main_108
  s_waitcnt vmcnt(1)
nt_main_108:
  v_cvt_pk_bf16_f32 v96, v24, v25
  v_cvt_pk_bf16_f32 v97, v26, v27
  v_cvt_pk_bf16_f32 v98, v28, v29
  v_cvt_pk_bf16_f32 v99, v30, v31
  s_add_u32 s33, s32, 8192
  buffer_store_dwordx4 v[96:99], v2, s[8:11], s33 offen sc1
  s_cmp_eq_u32 s22, 2
  s_cbranch_scc1 nt_main_109
  s_waitcnt vmcnt(1)
nt_main_109:
  v_cvt_pk_bf16_f32 v100, v32, v33
  v_cvt_pk_bf16_f32 v101, v34, v35
  v_cvt_pk_bf16_f32 v102, v36, v37
  v_cvt_pk_bf16_f32 v103, v38, v39
  s_add_u32 s33, s32, 303104
  buffer_store_dwordx4 v[100:103], v2, s[8:11], s33 offen sc1
  s_cmp_eq_u32 s22, 2
  s_cbranch_scc1 nt_main_110
  s_waitcnt vmcnt(1)
nt_main_110:
  v_cvt_pk_bf16_f32 v104, v40, v41
  v_cvt_pk_bf16_f32 v105, v42, v43
  v_cvt_pk_bf16_f32 v106, v44, v45
  v_cvt_pk_bf16_f32 v107, v46, v47
  s_add_u32 s33, s32, 16384
  buffer_store_dwordx4 v[104:107], v2, s[8:11], s33 offen sc1
  s_cmp_eq_u32 s22, 2
  s_cbranch_scc1 nt_main_111
  s_waitcnt vmcnt(1)
nt_main_111:
  v_cvt_pk_bf16_f32 v108, v48, v49
  v_cvt_pk_bf16_f32 v109, v50, v51
  v_cvt_pk_bf16_f32 v110, v52, v53
  v_cvt_pk_bf16_f32 v111, v54, v55
  s_add_u32 s33, s32, 311296
  buffer_store_dwordx4 v[108:111], v2, s[8:11], s33 offen sc1
  s_lshl_b32 s39, s21, 10
  s_add_u32 s39, s39, 122880
  s_cmp_eq_u32 s22, 2
  s_cbranch_scc1 nf_main_113
  s_lshl_b32 s33, s3, 5
  s_add_u32 s33, s33, s20
  s_lshl2_add_u32 s33, s33, s39
  s_mov_b64 exec, 1
  s_waitcnt vmcnt(0)
  buffer_store_dword v4, v2, s[8:11], s33 offen sc1
  s_mov_b64 exec, -1
nf_main_113:
  s_cmp_gt_u32 s3, 8
  s_cbranch_scc1 x_main_112
  s_setprio 0
  s_mov_b32 s48, s30
  s_mov_b32 s49, s31
  s_mov_b32 s50, 0x240000
  s_mov_b32 s51, 0x20000
  v_bfe_u32 v4, v0, 4, 2
  v_lshlrev_b32 v4, 4, v4
  buffer_load_dwordx4 v[56:59], v4, s[8:11], s36 offen
  s_lshl_b32 s33, s37, 13
  s_add_u32 s33, s33, 29097984
  s_add_u32 s34, s33, 4096
  v_and_b32 v6, 7, v1
  v_lshlrev_b32 v6, 2, v6
  s_and_b32 s38, s20, 3
  s_lshl2_add_u32 s38, s22, s38
  s_lshl_b32 s38, s38, 7
  s_add_u32 s39, s39, s38
  s_mov_b32 s38, 0
  s_mov_b32 s40, 0x3f80
  s_mov_b32 s41, 0x3f800000
  s_cmp_eq_u32 s22, 2
  s_cbranch_scc1 fp_main_116
  s_mov_b32 s35, s33
  s_mul_i32 s32, s22, 0
  s_cmp_eq_u32 s23, 3
  s_cselect_b32 s32, 12, s32
  v_add_u32 v165, s32, v165
  ds_read_b32 v166, v165 offset:72
  s_waitcnt lgkmcnt(0)
  v_readfirstlane_b32 s32, v166
  s_cmp_lg_u32 s32, 0x1010101
  s_cbranch_scc1 cw_main_117
cr_main_118:
  s_mov_b32 s33, s35
  s_cmp_eq_u32 s23, 3
  s_cbranch_scc1 fp_main_116
pr_main_119:
  buffer_load_dword v8, v6, s[8:11], s39 offen offset:0 sc1
  s_add_u32 s38, s38, 1
  s_waitcnt vmcnt(0)
  v_cmp_ne_u32 vcc, 1, v8
  s_nop 0
  s_cbranch_vccz pg_main_120
  s_sleep 4
  s_cmp_lt_u32 s38, 16384
  s_cbranch_scc1 pr_main_119
pg_main_120:
  s_branch f_main_114
fp_main_116:
  v_lshlrev_b32 v6, 8, v6
pr_main_121:
  buffer_load_dword v8, v6, s[8:11], s33 offen offset:1020 sc1
  s_add_u32 s38, s38, 1
  s_waitcnt vmcnt(0)
  v_cmp_eq_u32 vcc, -1, v8
  s_nop 0
  s_cbranch_vccz pg_main_122
  s_sleep 1
  s_cmp_lt_u32 s38, 16384
  s_cbranch_scc1 pr_main_121
pg_main_122:
f_main_114:
  buffer_load_dwordx4 v[112:115], v2, s[8:11], s33 offen offset:0 sc1
  buffer_load_dwordx4 v[116:119], v2, s[8:11], s33 offen offset:1024 sc1
  buffer_load_dwordx4 v[120:123], v2, s[8:11], s33 offen offset:2048 sc1
  buffer_load_dwordx4 v[124:127], v2, s[8:11], s33 offen offset:3072 sc1
  buffer_load_dwordx4 v[128:131], v2, s[8:11], s34 offen offset:0 sc1
  buffer_load_dwordx4 v[132:135], v2, s[8:11], s34 offen offset:1024 sc1
  buffer_load_dwordx4 v[136:139], v2, s[8:11], s34 offen offset:2048 sc1
  buffer_load_dwordx4 v[140:143], v2, s[8:11], s34 offen offset:3072 sc1
  v_mov_b32 v8, 0
  v_mov_b32 v9, 0
  v_mov_b32 v10, 0
  v_mov_b32 v11, 0
  v_mov_b32 v12, 0
  v_mov_b32 v13, 0
  v_mov_b32 v14, 0
  v_mov_b32 v15, 0
  v_mov_b32 v16, 0
  s_add_u32 s38, s38, 1
  s_waitcnt vmcnt(7)
  v_dot2c_f32_bf16 v8, s40, v112
  v_dot2c_f32_bf16 v9, s41, v112
  v_dot2c_f32_bf16 v10, s40, v113
  v_dot2c_f32_bf16 v11, s41, v113
  v_dot2c_f32_bf16 v12, s40, v114
  v_dot2c_f32_bf16 v13, s41, v114
  v_dot2c_f32_bf16 v14, s40, v115
  v_dot2c_f32_bf16 v15, s41, v115
  v_max3_u32 v16, v16, v112, v113
  v_max3_u32 v16, v16, v114, v115
  s_waitcnt vmcnt(6)
  v_dot2c_f32_bf16 v8, s40, v116
  v_dot2c_f32_bf16 v9, s41, v116
  v_dot2c_f32_bf16 v10, s40, v117
  v_dot2c_f32_bf16 v11, s41, v117
  v_dot2c_f32_bf16 v12, s40, v118
  v_dot2c_f32_bf16 v13, s41, v118
  v_dot2c_f32_bf16 v14, s40, v119
  v_dot2c_f32_bf16 v15, s41, v119
  v_max3_u32 v16, v16, v116, v117
  v_max3_u32 v16, v16, v118, v119
  s_waitcnt vmcnt(5)
  v_dot2c_f32_bf16 v8, s40, v120
  v_dot2c_f32_bf16 v9, s41, v120
  v_dot2c_f32_bf16 v10, s40, v121
  v_dot2c_f32_bf16 v11, s41, v121
  v_dot2c_f32_bf16 v12, s40, v122
  v_dot2c_f32_bf16 v13, s41, v122
  v_dot2c_f32_bf16 v14, s40, v123
  v_dot2c_f32_bf16 v15, s41, v123
  v_max3_u32 v16, v16, v120, v121
  v_max3_u32 v16, v16, v122, v123
  s_waitcnt vmcnt(4)
  v_dot2c_f32_bf16 v8, s40, v124
  v_dot2c_f32_bf16 v9, s41, v124
  v_dot2c_f32_bf16 v10, s40, v125
  v_dot2c_f32_bf16 v11, s41, v125
  v_dot2c_f32_bf16 v12, s40, v126
  v_dot2c_f32_bf16 v13, s41, v126
  v_dot2c_f32_bf16 v14, s40, v127
  v_dot2c_f32_bf16 v15, s41, v127
  v_max3_u32 v16, v16, v124, v125
  v_max3_u32 v16, v16, v126, v127
  s_waitcnt vmcnt(3)
  v_dot2c_f32_bf16 v8, s40, v128
  v_dot2c_f32_bf16 v9, s41, v128
  v_dot2c_f32_bf16 v10, s40, v129
  v_dot2c_f32_bf16 v11, s41, v129
  v_dot2c_f32_bf16 v12, s40, v130
  v_dot2c_f32_bf16 v13, s41, v130
  v_dot2c_f32_bf16 v14, s40, v131
  v_dot2c_f32_bf16 v15, s41, v131
  v_max3_u32 v16, v16, v128, v129
  v_max3_u32 v16, v16, v130, v131
  s_waitcnt vmcnt(2)
  v_dot2c_f32_bf16 v8, s40, v132
  v_dot2c_f32_bf16 v9, s41, v132
  v_dot2c_f32_bf16 v10, s40, v133
  v_dot2c_f32_bf16 v11, s41, v133
  v_dot2c_f32_bf16 v12, s40, v134
  v_dot2c_f32_bf16 v13, s41, v134
  v_dot2c_f32_bf16 v14, s40, v135
  v_dot2c_f32_bf16 v15, s41, v135
  v_max3_u32 v16, v16, v132, v133
  v_max3_u32 v16, v16, v134, v135
  s_waitcnt vmcnt(1)
  v_dot2c_f32_bf16 v8, s40, v136
  v_dot2c_f32_bf16 v9, s41, v136
  v_dot2c_f32_bf16 v10, s40, v137
  v_dot2c_f32_bf16 v11, s41, v137
  v_dot2c_f32_bf16 v12, s40, v138
  v_dot2c_f32_bf16 v13, s41, v138
  v_dot2c_f32_bf16 v14, s40, v139
  v_dot2c_f32_bf16 v15, s41, v139
  v_max3_u32 v16, v16, v136, v137
  v_max3_u32 v16, v16, v138, v139
  s_waitcnt vmcnt(0)
  v_dot2c_f32_bf16 v8, s40, v140
  v_dot2c_f32_bf16 v9, s41, v140
  v_dot2c_f32_bf16 v10, s40, v141
  v_dot2c_f32_bf16 v11, s41, v141
  v_dot2c_f32_bf16 v12, s40, v142
  v_dot2c_f32_bf16 v13, s41, v142
  v_dot2c_f32_bf16 v14, s40, v143
  v_dot2c_f32_bf16 v15, s41, v143
  v_max3_u32 v16, v16, v140, v141
  v_max3_u32 v16, v16, v142, v143
  v_cmp_eq_u32 vcc, -1, v16
  s_nop 0
  s_cbranch_vccz d_main_115
  s_cmp_lt_u32 s38, 16384
  s_cbranch_scc1 f_main_114
d_main_115:
  v_lshlrev_b32 v20, 16, v160
  v_and_b32 v21, 0xffff0000, v160
  v_lshlrev_b32 v22, 16, v161
  v_and_b32 v23, 0xffff0000, v161
  v_lshlrev_b32 v24, 16, v162
  v_and_b32 v25, 0xffff0000, v162
  v_lshlrev_b32 v26, 16, v163
  v_and_b32 v27, 0xffff0000, v163
  v_fmac_f32 v20, v56, v8
  v_fmac_f32 v21, v57, v9
  v_fmac_f32 v22, v58, v10
  v_fmac_f32 v23, v59, v11
  v_fmac_f32 v24, v56, v12
  v_fmac_f32 v25, v57, v13
  v_fmac_f32 v26, v58, v14
  v_fmac_f32 v27, v59, v15
  v_cvt_pk_bf16_f32 v28, v20, v21
  v_cvt_pk_bf16_f32 v29, v22, v23
  v_cvt_pk_bf16_f32 v30, v24, v25
  v_cvt_pk_bf16_f32 v31, v26, v27
  s_mov_b32 s33, 18432
  buffer_store_dwordx2 v[28:29], v164, s[48:51], 0 offen
  buffer_store_dwordx2 v[30:31], v164, s[48:51], s33 offen
x_main_112:
E_main_1:
  s_endpgm
cw_main_53:
  s_mov_b32 s33, 0
sp_main_123:
  s_sleep 6
  ds_read_b32 v166, v165 offset:100
  s_add_u32 s33, s33, 1
  s_waitcnt lgkmcnt(0)
  v_readfirstlane_b32 s32, v166
  s_cmp_eq_u32 s32, 0x1010101
  s_cbranch_scc1 cr_main_54
  s_cmp_lt_u32 s33, 4194304
  s_cbranch_scc1 sp_main_123
  s_branch cr_main_54
cw_main_55:
  s_mov_b32 s33, 0
sp_main_124:
  s_sleep 8
  ds_read_b32 v166, v165 offset:112
  s_add_u32 s33, s33, 1
  s_waitcnt lgkmcnt(0)
  v_readfirstlane_b32 s32, v166
  s_cmp_eq_u32 s32, 0x1010101
  s_cbranch_scc1 cr_main_56
  s_cmp_lt_u32 s33, 4194304
  s_cbranch_scc1 sp_main_124
  s_branch cr_main_56
cw_main_57:
  s_mov_b32 s33, 0
sp_main_125:
  s_sleep 2
  ds_read_b32 v166, v165 offset:116
  s_add_u32 s33, s33, 1
  s_waitcnt lgkmcnt(0)
  v_readfirstlane_b32 s32, v166
  s_cmp_eq_u32 s32, 0x1010101
  s_cbranch_scc1 cr_main_58
  s_cmp_lt_u32 s33, 4194304
  s_cbranch_scc1 sp_main_125
  s_branch cr_main_58
cw_main_59:
  s_mov_b32 s33, 0
sp_main_126:
  s_sleep 8
  ds_read_b32 v166, v165 offset:112
  s_add_u32 s33, s33, 1
  s_waitcnt lgkmcnt(0)
  v_readfirstlane_b32 s32, v166
  s_cmp_eq_u32 s32, 0x1010101
  s_cbranch_scc1 cr_main_60
  s_cmp_lt_u32 s33, 4194304
  s_cbranch_scc1 sp_main_126
  s_branch cr_main_60
cw_main_61:
  s_mov_b32 s33, 0
sp_main_127:
  s_sleep 2
  ds_read_b32 v166, v165 offset:116
  s_add_u32 s33, s33, 1
  s_waitcnt lgkmcnt(0)
  v_readfirstlane_b32 s32, v166
  s_cmp_eq_u32 s32, 0x1010101
  s_cbranch_scc1 cr_main_62
  s_cmp_lt_u32 s33, 4194304
  s_cbranch_scc1 sp_main_127
  s_branch cr_main_62
cw_main_64:
  s_mov_b32 s33, 0
sp_main_128:
  s_sleep 1
  ds_read_b32 v166, v165 offset:108
  s_add_u32 s33, s33, 1
  s_waitcnt lgkmcnt(0)
  v_readfirstlane_b32 s32, v166
  s_cmp_eq_u32 s32, 0x1010101
  s_cbranch_scc1 cr_main_65
  s_cmp_lt_u32 s33, 4194304
  s_cbranch_scc1 sp_main_128
  s_branch cr_main_65
cw_main_71:
  s_mov_b32 s33, 0
sp_main_129:
  s_sleep 1
  ds_read_b32 v166, v165 offset:124
  s_add_u32 s33, s33, 1
  s_waitcnt lgkmcnt(0)
  v_readfirstlane_b32 s32, v166
  s_cmp_eq_u32 s32, 0x1010101
  s_cbranch_scc1 cr_main_72
  s_cmp_lt_u32 s33, 4194304
  s_cbranch_scc1 sp_main_129
  s_branch cr_main_72
cw_main_75:
  s_mov_b32 s33, 0
sp_main_130:
  s_sleep 1
  ds_read_b32 v166, v165 offset:16
  s_add_u32 s33, s33, 1
  s_waitcnt lgkmcnt(0)
  v_readfirstlane_b32 s32, v166
  s_cmp_eq_u32 s32, 0x1010101
  s_cbranch_scc1 cr_main_76
  s_cmp_lt_u32 s33, 4194304
  s_cbranch_scc1 sp_main_130
  s_branch cr_main_76
cw_main_77:
  s_mov_b32 s33, 0
sp_main_131:
  s_sleep 1
  ds_read_b32 v166, v165 offset:120
  s_add_u32 s33, s33, 1
  s_waitcnt lgkmcnt(0)
  v_readfirstlane_b32 s32, v166
  s_cmp_eq_u32 s32, 0x1010101
  s_cbranch_scc1 cr_main_78
  s_cmp_lt_u32 s33, 4194304
  s_cbranch_scc1 sp_main_131
  s_branch cr_main_78
cw_main_89:
  s_mov_b32 s33, 0
sp_main_132:
  s_sleep 1
  ds_read_u8 v166, v6 offset:28
  s_add_u32 s33, s33, 1
  s_waitcnt lgkmcnt(0)
  v_readfirstlane_b32 s32, v166
  s_cmp_eq_u32 s32, 0x1
  s_cbranch_scc1 cr_main_90
  s_cmp_lt_u32 s33, 4194304
  s_cbranch_scc1 sp_main_132
  s_branch cr_main_90
cw_main_91:
  s_mov_b32 s33, 0
sp_main_133:
  s_sleep 1
  ds_read_b32 v166, v165 offset:16
  s_add_u32 s33, s33, 1
  s_waitcnt lgkmcnt(0)
  v_readfirstlane_b32 s32, v166
  s_cmp_eq_u32 s32, 0x1010101
  s_cbranch_scc1 cr_main_92
  s_cmp_lt_u32 s33, 4194304
  s_cbranch_scc1 sp_main_133
  s_branch cr_main_92
cw_main_93:
  s_mov_b32 s33, 0
sp_main_134:
  s_sleep 1
  ds_read_b32 v166, v165 offset:20
  s_add_u32 s33, s33, 1
  s_waitcnt lgkmcnt(0)
  v_readfirstlane_b32 s32, v166
  s_cmp_eq_u32 s32, 0x1010101
  s_cbranch_scc1 cr_main_94
  s_cmp_lt_u32 s33, 4194304
  s_cbranch_scc1 sp_main_134
  s_branch cr_main_94
cw_main_95:
  s_mov_b32 s33, 0
sp_main_135:
  s_sleep 1
  ds_read_b32 v166, v165 offset:24
  s_add_u32 s33, s33, 1
  s_waitcnt lgkmcnt(0)
  v_readfirstlane_b32 s32, v166
  s_cmp_eq_u32 s32, 0x1010101
  s_cbranch_scc1 cr_main_96
  s_cmp_lt_u32 s33, 4194304
  s_cbranch_scc1 sp_main_135
  s_branch cr_main_96
cw_main_97:
  s_mov_b32 s33, 0
sp_main_136:
  s_sleep 1
  ds_read_b32 v166, v165 offset:12
  s_add_u32 s33, s33, 1
  s_waitcnt lgkmcnt(0)
  v_readfirstlane_b32 s32, v166
  s_cmp_eq_u32 s32, 0x1010101
  s_cbranch_scc1 cr_main_98
  s_cmp_lt_u32 s33, 4194304
  s_cbranch_scc1 sp_main_136
  s_branch cr_main_98
cw_main_99:
  s_mov_b32 s33, 0
sp_main_137:
  s_sleep 1
  ds_read_u8 v166, v6 offset:40
  s_add_u32 s33, s33, 1
  s_waitcnt lgkmcnt(0)
  v_readfirstlane_b32 s32, v166
  s_cmp_eq_u32 s32, 0x1
  s_cbranch_scc1 cr_main_100
  s_cmp_lt_u32 s33, 4194304
  s_cbranch_scc1 sp_main_137
  s_branch cr_main_100
cw_main_101:
  s_mov_b32 s33, 0
sp_main_138:
  s_sleep 1
  ds_read_b32 v166, v165 offset:0
  s_add_u32 s33, s33, 1
  s_waitcnt lgkmcnt(0)
  v_readfirstlane_b32 s32, v166
  s_cmp_eq_u32 s32, 0x1010101
  s_cbranch_scc1 cr_main_102
  s_cmp_lt_u32 s33, 4194304
  s_cbranch_scc1 sp_main_138
  s_branch cr_main_102
cw_main_103:
  s_mov_b32 s33, 0
sp_main_139:
  s_sleep 1
  ds_read_b32 v166, v165 offset:4
  s_add_u32 s33, s33, 1
  s_waitcnt lgkmcnt(0)
  v_readfirstlane_b32 s32, v166
  s_cmp_eq_u32 s32, 0x1010101
  s_cbranch_scc1 cr_main_104
  s_cmp_lt_u32 s33, 4194304
  s_cbranch_scc1 sp_main_139
  s_branch cr_main_104
cw_main_105:
  s_mov_b32 s33, 0
sp_main_140:
  s_sleep 1
  ds_read_b32 v166, v165 offset:8
  s_add_u32 s33, s33, 1
  s_waitcnt lgkmcnt(0)
  v_readfirstlane_b32 s32, v166
  s_cmp_eq_u32 s32, 0x1010101
  s_cbranch_scc1 cr_main_106
  s_cmp_lt_u32 s33, 4194304
  s_cbranch_scc1 sp_main_140
  s_branch cr_main_106
cw_main_117:
  s_mov_b32 s33, 0
sp_main_141:
  s_sleep 1
  ds_read_b32 v166, v165 offset:72
  s_add_u32 s33, s33, 1
  s_waitcnt lgkmcnt(0)
  v_readfirstlane_b32 s32, v166
  s_cmp_eq_u32 s32, 0x1010101
  s_cbranch_scc1 cr_main_118
  s_cmp_lt_u32 s33, 4194304
  s_cbranch_scc1 sp_main_141
  s_branch cr_main_118
gs_main_81:
  s_waitcnt lgkmcnt(0)
  s_add_u32 s32, s33, 0
  buffer_load_dwordx4 v[16:19], v2, s[8:11], s32 offen sc1
  buffer_load_dwordx4 v[20:23], v2, s[8:11], s32 offen offset:1024 sc1
  s_add_u32 s32, s33, 4096
  buffer_load_dwordx4 v[24:27], v2, s[8:11], s32 offen sc1
  buffer_load_dwordx4 v[28:31], v2, s[8:11], s32 offen offset:1024 sc1
  s_add_u32 s32, s33, 8192
  buffer_load_dwordx4 v[32:35], v2, s[8:11], s32 offen sc1
  buffer_load_dwordx4 v[36:39], v2, s[8:11], s32 offen offset:1024 sc1
  s_add_u32 s38, s38, 1
  s_waitcnt vmcnt(0)
  v_swap_b32 v18, v20
  v_swap_b32 v19, v21
  ds_write_b128 v5, v[16:19] offset:0
  ds_write_b128 v5, v[20:23] offset:1024
  v_max3_u32 v8, 0, v16, v17
  v_max3_u32 v8, v8, v18, v19
  v_max3_u32 v8, v8, v20, v21
  v_max3_u32 v8, v8, v22, v23
  v_swap_b32 v26, v28
  v_swap_b32 v27, v29
  ds_write_b128 v5, v[24:27] offset:8192
  ds_write_b128 v5, v[28:31] offset:9216
  v_max3_u32 v8, v8, v24, v25
  v_max3_u32 v8, v8, v26, v27
  v_max3_u32 v8, v8, v28, v29
  v_max3_u32 v8, v8, v30, v31
  v_swap_b32 v34, v36
  v_swap_b32 v35, v37
  ds_write_b128 v5, v[32:35] offset:16384
  ds_write_b128 v5, v[36:39] offset:17408
  v_max3_u32 v8, v8, v32, v33
  v_max3_u32 v8, v8, v34, v35
  v_max3_u32 v8, v8, v36, v37
  v_max3_u32 v8, v8, v38, v39
  v_cmp_eq_u32 vcc, -1, v8
  s_nop 0
  s_cbranch_vccz gr_main_82
  s_cmp_lt_u32 s38, 16384
  s_cbranch_scc1 gs_main_81
  s_branch gr_main_82
gs_main_83:
  s_waitcnt lgkmcnt(0)
  s_add_u32 s32, s33, 12288
  buffer_load_dwordx4 v[40:43], v2, s[8:11], s32 offen sc1
  buffer_load_dwordx4 v[44:47], v2, s[8:11], s32 offen offset:1024 sc1
  s_add_u32 s32, s33, 16384
  buffer_load_dwordx4 v[48:51], v2, s[8:11], s32 offen sc1
  buffer_load_dwordx4 v[52:55], v2, s[8:11], s32 offen offset:1024 sc1
  s_add_u32 s32, s33, 20480
  buffer_load_dwordx4 v[56:59], v2, s[8:11], s32 offen sc1
  buffer_load_dwordx4 v[60:63], v2, s[8:11], s32 offen offset:1024 sc1
  s_add_u32 s38, s38, 1
  s_waitcnt vmcnt(0)
  v_swap_b32 v42, v44
  v_swap_b32 v43, v45
  ds_write_b128 v5, v[40:43] offset:24576
  ds_write_b128 v5, v[44:47] offset:25600
  v_max3_u32 v8, 0, v40, v41
  v_max3_u32 v8, v8, v42, v43
  v_max3_u32 v8, v8, v44, v45
  v_max3_u32 v8, v8, v46, v47
  v_swap_b32 v50, v52
  v_swap_b32 v51, v53
  ds_write_b128 v11, v[48:51] offset:0
  ds_write_b128 v11, v[52:55] offset:1024
  v_max3_u32 v8, v8, v48, v49
  v_max3_u32 v8, v8, v50, v51
  v_max3_u32 v8, v8, v52, v53
  v_max3_u32 v8, v8, v54, v55
  v_swap_b32 v58, v60
  v_swap_b32 v59, v61
  ds_write_b128 v11, v[56:59] offset:8192
  ds_write_b128 v11, v[60:63] offset:9216
  v_max3_u32 v8, v8, v56, v57
  v_max3_u32 v8, v8, v58, v59
  v_max3_u32 v8, v8, v60, v61
  v_max3_u32 v8, v8, v62, v63
  v_cmp_eq_u32 vcc, -1, v8
  s_nop 0
  s_cbranch_vccz gr_main_84
  s_cmp_lt_u32 s38, 16384
  s_cbranch_scc1 gs_main_83
  s_branch gr_main_84
gs_main_85:
  s_waitcnt lgkmcnt(0)
  s_add_u32 s32, s33, 24576
  buffer_load_dwordx4 v[64:67], v2, s[8:11], s32 offen sc1
  buffer_load_dwordx4 v[68:71], v2, s[8:11], s32 offen offset:1024 sc1
  s_add_u32 s32, s33, 28672
  buffer_load_dwordx4 v[72:75], v2, s[8:11], s32 offen sc1
  buffer_load_dwordx4 v[76:79], v2, s[8:11], s32 offen offset:1024 sc1
  s_add_u32 s32, s33, 32768
  buffer_load_dwordx4 v[80:83], v2, s[8:11], s32 offen sc1
  buffer_load_dwordx4 v[84:87], v2, s[8:11], s32 offen offset:1024 sc1
  s_add_u32 s38, s38, 1
  s_waitcnt vmcnt(0)
  v_swap_b32 v66, v68
  v_swap_b32 v67, v69
  ds_write_b128 v11, v[64:67] offset:16384
  ds_write_b128 v11, v[68:71] offset:17408
  v_max3_u32 v8, 0, v64, v65
  v_max3_u32 v8, v8, v66, v67
  v_max3_u32 v8, v8, v68, v69
  v_max3_u32 v8, v8, v70, v71
  v_swap_b32 v74, v76
  v_swap_b32 v75, v77
  ds_write_b128 v11, v[72:75] offset:24576
  ds_write_b128 v11, v[76:79] offset:25600
  v_max3_u32 v8, v8, v72, v73
  v_max3_u32 v8, v8, v74, v75
  v_max3_u32 v8, v8, v76, v77
  v_max3_u32 v8, v8, v78, v79
  v_swap_b32 v82, v84
  v_swap_b32 v83, v85
  ds_write_b128 v11, v[80:83] offset:32768
  ds_write_b128 v11, v[84:87] offset:33792
  v_max3_u32 v8, v8, v80, v81
  v_max3_u32 v8, v8, v82, v83
  v_max3_u32 v8, v8, v84, v85
  v_max3_u32 v8, v8, v86, v87
  v_cmp_eq_u32 vcc, -1, v8
  s_nop 0
  s_cbranch_vccz gr_main_86
  s_cmp_lt_u32 s38, 16384
  s_cbranch_scc1 gs_main_85
  s_branch gr_main_86
.section .rodata,"a"
.p2align 6
.amdhsa_kernel prep_kernel
  .amdhsa_next_free_vgpr 76
  .amdhsa_next_free_sgpr 42
  .amdhsa_accum_offset 76
  .amdhsa_group_segment_fixed_size 0
  .amdhsa_kernarg_size 88
  .amdhsa_user_sgpr_count 2
  .amdhsa_user_sgpr_kernarg_segment_ptr 1
  .amdhsa_system_sgpr_workgroup_id_x 1
.end_amdhsa_kernel
.section .rodata,"a"
.p2align 6
.amdhsa_kernel main_kernel
  .amdhsa_next_free_vgpr 168
  .amdhsa_next_free_sgpr 52
  .amdhsa_accum_offset 168
  .amdhsa_group_segment_fixed_size 0
  .amdhsa_kernarg_size 88
  .amdhsa_user_sgpr_count 2
  .amdhsa_user_sgpr_kernarg_segment_ptr 1
  .amdhsa_system_sgpr_workgroup_id_x 1
.end_amdhsa_kernel
```
